```python
import torch

def _softmax(x, axis=-1):
    return torch.softmax(x, dim=axis)
def _gelu(x):
    return torch.nn.functional.gelu(x, approximate="tanh")
def _silu(x):
    return torch.nn.functional.silu(x)
def _sigmoid(x):
    return torch.sigmoid(x)
def _layernorm(x, axis=-1, eps=1e-5):
    m = x.mean(dim=axis, keepdim=True)
    v = x.var(dim=axis, keepdim=True, unbiased=False)
    return (x - m) / torch.sqrt(v + eps)
def _scatter_add(tgt, idx, src, axis=0):
    return tgt.clone().index_add_(axis, idx, src)
def _segment_sum(src, seg, n):
    out = torch.zeros((n,) + src.shape[1:], dtype=src.dtype)
    return out.index_add_(0, seg, src)
def _pad(x, pw):
    flat = tuple(v for pair in reversed(pw) for v in pair)
    return torch.nn.functional.pad(x, flat)

kernel_name = 'standalone__kv_cache_quant_int4_int2_kv_with_per_channel_or_per_token_scales__sampling'

def setup_inputs():

    _w = (lambda a: (lambda t: t.to(torch.bfloat16) if t.is_floating_point() else t)(torch.as_tensor(a)))
    B = 16
    Sq = 16
    Skv = 4096
    Hq = 32
    Hkv = 4
    Dh = 128
    bits = 2
    G = 32
    if G <= 0 or G >= Skv:
        G = max(1, Skv // 2)
    Skv = (Skv // G) * G
    ngk = Skv // G
    qmax = (1 << bits) - 1
    return {
        "q": _w((lambda *s: torch.randn(*s, dtype=torch.bfloat16) * 3.2)(B, Hq, Sq, Dh)),
        "qk": _w(torch.randint(0, qmax + 1, (B, Hkv, Skv, Dh)).to(torch.int32)),
        "qv": _w(torch.randint(0, qmax + 1, (B, Hkv, Skv, Dh)).to(torch.int32)),
        "k_scales": _w(torch.abs((lambda *s: torch.randn(*s, dtype=torch.bfloat16) * 3.2)(B, Hkv, ngk, Dh)) * 0.05 + 0.02),
        "k_zeros": _w((lambda *s: torch.randn(*s, dtype=torch.bfloat16) * 3.2)(B, Hkv, ngk, Dh) + float(qmax) / 2.0),
        "v_scales": _w(torch.abs((lambda *s: torch.randn(*s, dtype=torch.bfloat16) * 0.05)(B, Hkv, Skv, 1)) * 0.05 + 0.02),
        "v_zeros": _w((lambda *s: torch.randn(*s, dtype=torch.bfloat16) * 0.05)(B, Hkv, Skv, 1) + float(qmax) / 2.0),
    }

def reference(q, qk, qv, k_scales, k_zeros, v_scales, v_zeros):
    B, Hq, Sq, Dh = q.shape
    Hkv, Skv = qk.shape[1], qk.shape[2]
    ngk = k_scales.shape[2]
    G = Skv // ngk
    ks = (lambda x, n, axis: torch.repeat_interleave(x, n, dim=axis))(k_scales, G, axis=2)
    kz = (lambda x, n, axis: torch.repeat_interleave(x, n, dim=axis))(k_zeros, G, axis=2)
    k = ((lambda x, dt: x.to(dt))(qk, q.dtype) - kz) * ks
    v = ((lambda x, dt: x.to(dt))(qv, q.dtype) - v_zeros) * v_scales
    rep = Hq // Hkv
    if rep > 1:
        k = (lambda x, n, axis: torch.repeat_interleave(x, n, dim=axis))(k, rep, axis=1)
        v = (lambda x, n, axis: torch.repeat_interleave(x, n, dim=axis))(v, rep, axis=1)
    scale = float(Dh) ** -0.5
    logits = torch.einsum("bhqd,bhkd->bhqk", q, k) * scale
    p = _softmax(logits, axis=-1)
    o = torch.einsum("bhqk,bhkd->bhqd", p, v)
    return o
```

```asm
; @launch grid=(256,1,1) block=(512,1,1) lds=143424
.amdgcn_target "amdgcn-amd-amdhsa--gfx950"
.text
.globl standalone__kv_cache_quant_int4_int2_kv_with_per_channel_or_per_token_scales__sampling_kernel
.p2align 8
.type standalone__kv_cache_quant_int4_int2_kv_with_per_channel_or_per_token_scales__sampling_kernel,@function
standalone__kv_cache_quant_int4_int2_kv_with_per_channel_or_per_token_scales__sampling_kernel:
    s_cmp_ge_u32 s2, 256
    s_cbranch_scc1 L_end
    s_load_dwordx16 s[16:31], s[0:1], 0
    s_load_dwordx4 s[32:35], s[0:1], 64
    s_and_b32 s72, s2, 63
    s_lshr_b32 s73, s2, 6
    v_lshrrev_b32 v10, 6, v0
    v_and_b32 v11, 63, v0
    v_readfirstlane_b32 s74, v10
    v_and_b32 v10, 3, v10
    v_and_b32 v12, 31, v0
    v_bfe_u32 v13, v0, 5, 1
    s_mov_b32 s76, 0
    s_cmp_lt_u32 s74, 4
    s_cbranch_scc1 L_consumer
    v_lshlrev_b32 v1, 13, v10
    v_lshl_add_u32 v1, v13, 12, v1
    v_lshl_add_u32 v1, v12, 4, v1
    s_lshl_b32 s75, s73, 15
    s_add_u32 s97, s75, 0x20000
    s_waitcnt lgkmcnt(0)
    s_lshl_b32 s80, s72, 21
    s_add_u32 s36, s18, s80
    s_addc_u32 s37, s19, 0
    s_and_b32 s37, s37, 0xffff
    s_mov_b32 s38, 2097152
    s_mov_b32 s39, 0x00020000
    buffer_load_dwordx4 v[56:59], v1, s[36:39], s75 offen offset:0 nt
    buffer_load_dwordx4 v[60:63], v1, s[36:39], s75 offen offset:512 nt
    buffer_load_dwordx4 v[64:67], v1, s[36:39], s75 offen offset:1024 nt
    buffer_load_dwordx4 v[68:71], v1, s[36:39], s75 offen offset:1536 nt
    buffer_load_dwordx4 v[72:75], v1, s[36:39], s75 offen offset:2048 nt
    buffer_load_dwordx4 v[76:79], v1, s[36:39], s75 offen offset:2560 nt
    buffer_load_dwordx4 v[80:83], v1, s[36:39], s75 offen offset:3072 nt
    buffer_load_dwordx4 v[84:87], v1, s[36:39], s75 offen offset:3584 nt
    s_lshl_b32 s80, s72, 21
    s_add_u32 s40, s20, s80
    s_addc_u32 s41, s21, 0
    s_and_b32 s41, s41, 0xffff
    s_mov_b32 s42, 2097152
    s_mov_b32 s43, 0x00020000
    s_add_u32 s97, s75, 131072
    s_add_u32 s75, s75, 0
    v_lshlrev_b32 v14, 4, v10
    v_lshl_add_u32 v14, v13, 3, v14
    v_mul_u32_u24 v2, 272, v14
    v_lshl_add_u32 v2, v12, 3, v2
    v_lshlrev_b32 v3, 4, v11
    v_lshl_add_u32 v3, v10, 12, v3
    v_lshlrev_b32 v6, 7, v10
    v_lshl_add_u32 v6, v13, 6, v6
    v_add_u32 v6, 100352, v6
    v_lshrrev_b32 v14, 1, v10
    v_lshlrev_b32 v7, 10, v14
    v_lshl_add_u32 v7, v12, 4, v7
    v_add_u32 v7, 67584, v7
    s_barrier
    s_mov_b32 s3, 33792
    s_mov_b32 s96, 33792
    ds_read_b128 v[16:19], v7
    ds_read_b128 v[20:23], v7 offset:512
    ds_read_b128 v[24:27], v6 offset:0
    ds_read_b128 v[28:31], v6 offset:16
    ds_read_b128 v[32:35], v6 offset:32
    ds_read_b128 v[36:39], v6 offset:48
    v_add_u32 v7, 2048, v7
    v_add_u32 v6, 512, v6
    s_waitcnt vmcnt(7) lgkmcnt(4)
    v_cvt_f32_i32 v56, v56
    v_cvt_f32_i32 v57, v57
    v_cvt_f32_i32 v58, v58
    v_cvt_f32_i32 v59, v59
    v_pk_fma_f32 v[56:57], v[56:57], v[16:17], v[20:21]
    v_pk_fma_f32 v[58:59], v[58:59], v[18:19], v[22:23]
    v_cvt_pk_bf16_f32 v56, v56, v57
    v_cvt_pk_bf16_f32 v57, v58, v59
    ds_write_b64 v2, v[56:57] offset:0
    buffer_load_dwordx4 v[56:59], v1, s[40:43], s75 offen offset:0 nt
    s_waitcnt vmcnt(7)
    v_cvt_f32_i32 v60, v60
    v_cvt_f32_i32 v61, v61
    v_cvt_f32_i32 v62, v62
    v_cvt_f32_i32 v63, v63
    v_pk_fma_f32 v[60:61], v[60:61], v[16:17], v[20:21]
    v_pk_fma_f32 v[62:63], v[62:63], v[18:19], v[22:23]
    v_cvt_pk_bf16_f32 v60, v60, v61
    v_cvt_pk_bf16_f32 v61, v62, v63
    ds_write_b64 v2, v[60:61] offset:272
    buffer_load_dwordx4 v[60:63], v1, s[40:43], s75 offen offset:512 nt
    s_waitcnt vmcnt(7)
    v_cvt_f32_i32 v64, v64
    v_cvt_f32_i32 v65, v65
    v_cvt_f32_i32 v66, v66
    v_cvt_f32_i32 v67, v67
    v_pk_fma_f32 v[64:65], v[64:65], v[16:17], v[20:21]
    v_pk_fma_f32 v[66:67], v[66:67], v[18:19], v[22:23]
    v_cvt_pk_bf16_f32 v64, v64, v65
    v_cvt_pk_bf16_f32 v65, v66, v67
    ds_write_b64 v2, v[64:65] offset:544
    buffer_load_dwordx4 v[64:67], v1, s[40:43], s75 offen offset:1024 nt
    s_waitcnt vmcnt(7)
    v_cvt_f32_i32 v68, v68
    v_cvt_f32_i32 v69, v69
    v_cvt_f32_i32 v70, v70
    v_cvt_f32_i32 v71, v71
    v_pk_fma_f32 v[68:69], v[68:69], v[16:17], v[20:21]
    v_pk_fma_f32 v[70:71], v[70:71], v[18:19], v[22:23]
    v_cvt_pk_bf16_f32 v68, v68, v69
    v_cvt_pk_bf16_f32 v69, v70, v71
    ds_write_b64 v2, v[68:69] offset:816
    buffer_load_dwordx4 v[68:71], v1, s[40:43], s75 offen offset:1536 nt
    s_waitcnt vmcnt(7)
    v_cvt_f32_i32 v72, v72
    v_cvt_f32_i32 v73, v73
    v_cvt_f32_i32 v74, v74
    v_cvt_f32_i32 v75, v75
    v_pk_fma_f32 v[72:73], v[72:73], v[16:17], v[20:21]
    v_pk_fma_f32 v[74:75], v[74:75], v[18:19], v[22:23]
    v_cvt_pk_bf16_f32 v72, v72, v73
    v_cvt_pk_bf16_f32 v73, v74, v75
    ds_write_b64 v2, v[72:73] offset:1088
    buffer_load_dwordx4 v[72:75], v1, s[40:43], s75 offen offset:2048 nt
    s_waitcnt vmcnt(7)
    v_cvt_f32_i32 v76, v76
    v_cvt_f32_i32 v77, v77
    v_cvt_f32_i32 v78, v78
    v_cvt_f32_i32 v79, v79
    v_pk_fma_f32 v[76:77], v[76:77], v[16:17], v[20:21]
    v_pk_fma_f32 v[78:79], v[78:79], v[18:19], v[22:23]
    v_cvt_pk_bf16_f32 v76, v76, v77
    v_cvt_pk_bf16_f32 v77, v78, v79
    ds_write_b64 v2, v[76:77] offset:1360
    buffer_load_dwordx4 v[76:79], v1, s[40:43], s75 offen offset:2560 nt
    s_waitcnt vmcnt(7)
    v_cvt_f32_i32 v80, v80
    v_cvt_f32_i32 v81, v81
    v_cvt_f32_i32 v82, v82
    v_cvt_f32_i32 v83, v83
    v_pk_fma_f32 v[80:81], v[80:81], v[16:17], v[20:21]
    v_pk_fma_f32 v[82:83], v[82:83], v[18:19], v[22:23]
    v_cvt_pk_bf16_f32 v80, v80, v81
    v_cvt_pk_bf16_f32 v81, v82, v83
    ds_write_b64 v2, v[80:81] offset:1632
    buffer_load_dwordx4 v[80:83], v1, s[40:43], s75 offen offset:3072 nt
    s_waitcnt vmcnt(7)
    v_cvt_f32_i32 v84, v84
    v_cvt_f32_i32 v85, v85
    v_cvt_f32_i32 v86, v86
    v_cvt_f32_i32 v87, v87
    v_pk_fma_f32 v[84:85], v[84:85], v[16:17], v[20:21]
    v_pk_fma_f32 v[86:87], v[86:87], v[18:19], v[22:23]
    v_cvt_pk_bf16_f32 v84, v84, v85
    v_cvt_pk_bf16_f32 v85, v86, v87
    ds_write_b64 v2, v[84:85] offset:1904
    buffer_load_dwordx4 v[84:87], v1, s[40:43], s75 offen offset:3584 nt
    s_add_u32 s75, s75, 0x20000
    v_add_u32 v2, s3, v2
    s_sub_u32 s3, 0, s3
    s_waitcnt lgkmcnt(0)
    s_barrier
L_ploopA:
    s_waitcnt vmcnt(6)
    v_cvt_f32_i32 v56, v56
    v_cvt_f32_i32 v57, v57
    v_cvt_f32_i32 v58, v58
    v_cvt_f32_i32 v59, v59
    v_cvt_f32_i32 v60, v60
    v_cvt_f32_i32 v61, v61
    v_cvt_f32_i32 v62, v62
    v_cvt_f32_i32 v63, v63
    v_pk_fma_f32 v[56:57], v[56:57], v[24:25], v[24:25] op_sel:[0,0,1] op_sel_hi:[1,0,1]
    v_pk_fma_f32 v[58:59], v[58:59], v[24:25], v[24:25] op_sel:[0,0,1] op_sel_hi:[1,0,1]
    v_pk_fma_f32 v[60:61], v[60:61], v[26:27], v[26:27] op_sel:[0,0,1] op_sel_hi:[1,0,1]
    v_pk_fma_f32 v[62:63], v[62:63], v[26:27], v[26:27] op_sel:[0,0,1] op_sel_hi:[1,0,1]
    v_cvt_pk_bf16_f32 v40, v56, v60
    v_cvt_pk_bf16_f32 v44, v57, v61
    v_cvt_pk_bf16_f32 v48, v58, v62
    v_cvt_pk_bf16_f32 v52, v59, v63
    buffer_load_dwordx4 v[56:59], v1, s[36:39], s97 offen offset:0 nt
    buffer_load_dwordx4 v[60:63], v1, s[36:39], s97 offen offset:512 nt
    s_waitcnt vmcnt(6)
    v_cvt_f32_i32 v64, v64
    v_cvt_f32_i32 v65, v65
    v_cvt_f32_i32 v66, v66
    v_cvt_f32_i32 v67, v67
    v_cvt_f32_i32 v68, v68
    v_cvt_f32_i32 v69, v69
    v_cvt_f32_i32 v70, v70
    v_cvt_f32_i32 v71, v71
    v_pk_fma_f32 v[64:65], v[64:65], v[28:29], v[28:29] op_sel:[0,0,1] op_sel_hi:[1,0,1]
    v_pk_fma_f32 v[66:67], v[66:67], v[28:29], v[28:29] op_sel:[0,0,1] op_sel_hi:[1,0,1]
    v_pk_fma_f32 v[68:69], v[68:69], v[30:31], v[30:31] op_sel:[0,0,1] op_sel_hi:[1,0,1]
    v_pk_fma_f32 v[70:71], v[70:71], v[30:31], v[30:31] op_sel:[0,0,1] op_sel_hi:[1,0,1]
    v_cvt_pk_bf16_f32 v41, v64, v68
    v_cvt_pk_bf16_f32 v45, v65, v69
    v_cvt_pk_bf16_f32 v49, v66, v70
    v_cvt_pk_bf16_f32 v53, v67, v71
    buffer_load_dwordx4 v[64:67], v1, s[36:39], s97 offen offset:1024 nt
    buffer_load_dwordx4 v[68:71], v1, s[36:39], s97 offen offset:1536 nt
    s_waitcnt vmcnt(6)
    v_cvt_f32_i32 v72, v72
    v_cvt_f32_i32 v73, v73
    v_cvt_f32_i32 v74, v74
    v_cvt_f32_i32 v75, v75
    v_cvt_f32_i32 v76, v76
    v_cvt_f32_i32 v77, v77
    v_cvt_f32_i32 v78, v78
    v_cvt_f32_i32 v79, v79
    v_pk_fma_f32 v[72:73], v[72:73], v[32:33], v[32:33] op_sel:[0,0,1] op_sel_hi:[1,0,1]
    v_pk_fma_f32 v[74:75], v[74:75], v[32:33], v[32:33] op_sel:[0,0,1] op_sel_hi:[1,0,1]
    v_pk_fma_f32 v[76:77], v[76:77], v[34:35], v[34:35] op_sel:[0,0,1] op_sel_hi:[1,0,1]
    v_pk_fma_f32 v[78:79], v[78:79], v[34:35], v[34:35] op_sel:[0,0,1] op_sel_hi:[1,0,1]
    v_cvt_pk_bf16_f32 v42, v72, v76
    v_cvt_pk_bf16_f32 v46, v73, v77
    v_cvt_pk_bf16_f32 v50, v74, v78
    v_cvt_pk_bf16_f32 v54, v75, v79
    buffer_load_dwordx4 v[72:75], v1, s[36:39], s97 offen offset:2048 nt
    buffer_load_dwordx4 v[76:79], v1, s[36:39], s97 offen offset:2560 nt
    s_waitcnt vmcnt(6)
    v_cvt_f32_i32 v80, v80
    v_cvt_f32_i32 v81, v81
    v_cvt_f32_i32 v82, v82
    v_cvt_f32_i32 v83, v83
    v_cvt_f32_i32 v84, v84
    v_cvt_f32_i32 v85, v85
    v_cvt_f32_i32 v86, v86
    v_cvt_f32_i32 v87, v87
    v_pk_fma_f32 v[80:81], v[80:81], v[36:37], v[36:37] op_sel:[0,0,1] op_sel_hi:[1,0,1]
    v_pk_fma_f32 v[82:83], v[82:83], v[36:37], v[36:37] op_sel:[0,0,1] op_sel_hi:[1,0,1]
    v_pk_fma_f32 v[84:85], v[84:85], v[38:39], v[38:39] op_sel:[0,0,1] op_sel_hi:[1,0,1]
    v_pk_fma_f32 v[86:87], v[86:87], v[38:39], v[38:39] op_sel:[0,0,1] op_sel_hi:[1,0,1]
    v_cvt_pk_bf16_f32 v43, v80, v84
    v_cvt_pk_bf16_f32 v47, v81, v85
    v_cvt_pk_bf16_f32 v51, v82, v86
    v_cvt_pk_bf16_f32 v55, v83, v87
    buffer_load_dwordx4 v[80:83], v1, s[36:39], s97 offen offset:3072 nt
    buffer_load_dwordx4 v[84:87], v1, s[36:39], s97 offen offset:3584 nt
    ds_write_b128 v3, v[40:43] offset:17408
    ds_write_b128 v3, v[44:47] offset:18432
    ds_write_b128 v3, v[48:51] offset:19456
    ds_write_b128 v3, v[52:55] offset:20480
    s_add_u32 s97, s97, 0x20000
    v_add_u32 v3, s96, v3
    s_sub_u32 s96, 0, s96
    s_add_u32 s76, s76, 1
    s_cmp_eq_u32 s76, 16
    s_cbranch_scc1 L_plastA
L_pkA:
    ds_read_b128 v[16:19], v7
    ds_read_b128 v[20:23], v7 offset:512
    ds_read_b128 v[24:27], v6 offset:0
    ds_read_b128 v[28:31], v6 offset:16
    ds_read_b128 v[32:35], v6 offset:32
    ds_read_b128 v[36:39], v6 offset:48
    v_add_u32 v7, 2048, v7
    v_add_u32 v6, 512, v6
    s_waitcnt vmcnt(7) lgkmcnt(4)
    v_cvt_f32_i32 v56, v56
    v_cvt_f32_i32 v57, v57
    v_cvt_f32_i32 v58, v58
    v_cvt_f32_i32 v59, v59
    v_pk_fma_f32 v[56:57], v[56:57], v[16:17], v[20:21]
    v_pk_fma_f32 v[58:59], v[58:59], v[18:19], v[22:23]
    v_cvt_pk_bf16_f32 v56, v56, v57
    v_cvt_pk_bf16_f32 v57, v58, v59
    ds_write_b64 v2, v[56:57] offset:0
    buffer_load_dwordx4 v[56:59], v1, s[40:43], s75 offen offset:0 nt
    s_waitcnt vmcnt(7)
    v_cvt_f32_i32 v60, v60
    v_cvt_f32_i32 v61, v61
    v_cvt_f32_i32 v62, v62
    v_cvt_f32_i32 v63, v63
    v_pk_fma_f32 v[60:61], v[60:61], v[16:17], v[20:21]
    v_pk_fma_f32 v[62:63], v[62:63], v[18:19], v[22:23]
    v_cvt_pk_bf16_f32 v60, v60, v61
    v_cvt_pk_bf16_f32 v61, v62, v63
    ds_write_b64 v2, v[60:61] offset:272
    buffer_load_dwordx4 v[60:63], v1, s[40:43], s75 offen offset:512 nt
    s_waitcnt vmcnt(7)
    v_cvt_f32_i32 v64, v64
    v_cvt_f32_i32 v65, v65
    v_cvt_f32_i32 v66, v66
    v_cvt_f32_i32 v67, v67
    v_pk_fma_f32 v[64:65], v[64:65], v[16:17], v[20:21]
    v_pk_fma_f32 v[66:67], v[66:67], v[18:19], v[22:23]
    v_cvt_pk_bf16_f32 v64, v64, v65
    v_cvt_pk_bf16_f32 v65, v66, v67
    ds_write_b64 v2, v[64:65] offset:544
    buffer_load_dwordx4 v[64:67], v1, s[40:43], s75 offen offset:1024 nt
    s_waitcnt vmcnt(7)
    v_cvt_f32_i32 v68, v68
    v_cvt_f32_i32 v69, v69
    v_cvt_f32_i32 v70, v70
    v_cvt_f32_i32 v71, v71
    v_pk_fma_f32 v[68:69], v[68:69], v[16:17], v[20:21]
    v_pk_fma_f32 v[70:71], v[70:71], v[18:19], v[22:23]
    v_cvt_pk_bf16_f32 v68, v68, v69
    v_cvt_pk_bf16_f32 v69, v70, v71
    ds_write_b64 v2, v[68:69] offset:816
    buffer_load_dwordx4 v[68:71], v1, s[40:43], s75 offen offset:1536 nt
    s_waitcnt vmcnt(7)
    v_cvt_f32_i32 v72, v72
    v_cvt_f32_i32 v73, v73
    v_cvt_f32_i32 v74, v74
    v_cvt_f32_i32 v75, v75
    v_pk_fma_f32 v[72:73], v[72:73], v[16:17], v[20:21]
    v_pk_fma_f32 v[74:75], v[74:75], v[18:19], v[22:23]
    v_cvt_pk_bf16_f32 v72, v72, v73
    v_cvt_pk_bf16_f32 v73, v74, v75
    ds_write_b64 v2, v[72:73] offset:1088
    buffer_load_dwordx4 v[72:75], v1, s[40:43], s75 offen offset:2048 nt
    s_waitcnt vmcnt(7)
    v_cvt_f32_i32 v76, v76
    v_cvt_f32_i32 v77, v77
    v_cvt_f32_i32 v78, v78
    v_cvt_f32_i32 v79, v79
    v_pk_fma_f32 v[76:77], v[76:77], v[16:17], v[20:21]
    v_pk_fma_f32 v[78:79], v[78:79], v[18:19], v[22:23]
    v_cvt_pk_bf16_f32 v76, v76, v77
    v_cvt_pk_bf16_f32 v77, v78, v79
    ds_write_b64 v2, v[76:77] offset:1360
    buffer_load_dwordx4 v[76:79], v1, s[40:43], s75 offen offset:2560 nt
    s_waitcnt vmcnt(7)
    v_cvt_f32_i32 v80, v80
    v_cvt_f32_i32 v81, v81
    v_cvt_f32_i32 v82, v82
    v_cvt_f32_i32 v83, v83
    v_pk_fma_f32 v[80:81], v[80:81], v[16:17], v[20:21]
    v_pk_fma_f32 v[82:83], v[82:83], v[18:19], v[22:23]
    v_cvt_pk_bf16_f32 v80, v80, v81
    v_cvt_pk_bf16_f32 v81, v82, v83
    ds_write_b64 v2, v[80:81] offset:1632
    buffer_load_dwordx4 v[80:83], v1, s[40:43], s75 offen offset:3072 nt
    s_waitcnt vmcnt(7)
    v_cvt_f32_i32 v84, v84
    v_cvt_f32_i32 v85, v85
    v_cvt_f32_i32 v86, v86
    v_cvt_f32_i32 v87, v87
    v_pk_fma_f32 v[84:85], v[84:85], v[16:17], v[20:21]
    v_pk_fma_f32 v[86:87], v[86:87], v[18:19], v[22:23]
    v_cvt_pk_bf16_f32 v84, v84, v85
    v_cvt_pk_bf16_f32 v85, v86, v87
    ds_write_b64 v2, v[84:85] offset:1904
    buffer_load_dwordx4 v[84:87], v1, s[40:43], s75 offen offset:3584 nt
    s_add_u32 s75, s75, 0x20000
    v_add_u32 v2, s3, v2
    s_sub_u32 s3, 0, s3
    s_waitcnt lgkmcnt(0)
    s_barrier
    s_branch L_ploopA
L_plastA:
    s_waitcnt lgkmcnt(0)
    s_barrier
L_pdoneA:
    s_endpgm
L_consumer:
    v_lshrrev_b32 v14, 5, v0
    v_lshlrev_b32 v177, 11, v14
    v_lshl_add_u32 v177, v12, 4, v177
    v_lshrrev_b32 v14, 4, v0
    v_and_b32 v15, 15, v0
    v_lshlrev_b32 v178, 9, v14
    v_lshl_add_u32 v178, v15, 3, v178
    v_lshlrev_b32 v176, 10, v14
    v_lshl_add_u32 v176, v15, 5, v176
    v_add_u32 v176, 67584, v176
    v_lshlrev_b32 v179, 5, v0
    v_add_u32 v179, 100352, v179
    v_lshlrev_b32 v4, 4, v11
    v_lshl_add_u32 v14, v10, 13, v4
    v_add_u32 v15, 0x1000, v14
    s_lshl_b32 s82, s73, 9
    s_lshl_b32 s83, s73, 7
    s_waitcnt lgkmcnt(0)
    s_lshl_b32 s80, s72, 15
    s_add_u32 s48, s22, s80
    s_addc_u32 s49, s23, 0
    s_and_b32 s49, s49, 0xffff
    s_mov_b32 s50, 32768
    s_mov_b32 s51, 0x00020000
    s_lshl_b32 s80, s72, 15
    s_add_u32 s52, s24, s80
    s_addc_u32 s53, s25, 0
    s_and_b32 s53, s53, 0xffff
    s_mov_b32 s54, 32768
    s_mov_b32 s55, 0x00020000
    buffer_load_dwordx4 v[16:19], v177, s[48:51], s82 offen nt
    buffer_load_dwordx4 v[20:23], v177, s[52:55], s82 offen nt
    s_lshl_b32 s80, s72, 13
    s_add_u32 s56, s26, s80
    s_addc_u32 s57, s27, 0
    s_and_b32 s57, s57, 0xffff
    s_mov_b32 s58, 8192
    s_mov_b32 s59, 0x00020000
    s_lshl_b32 s80, s72, 13
    s_add_u32 s60, s28, s80
    s_addc_u32 s61, s29, 0
    s_and_b32 s61, s61, 0xffff
    s_mov_b32 s62, 8192
    s_mov_b32 s63, 0x00020000
    buffer_load_dwordx2 v[32:33], v178, s[56:59], s83 offen nt
    buffer_load_dwordx2 v[34:35], v178, s[60:63], s83 offen nt
    s_lshl_b32 s80, s72, 15
    s_add_u32 s44, s16, s80
    s_addc_u32 s45, s17, 0
    s_and_b32 s45, s45, 0xffff
    s_mov_b32 s46, 32768
    s_mov_b32 s47, 0x00020000
    buffer_load_dwordx4 v[112:115], v14, s[44:47], 0 offen offset:0
    buffer_load_dwordx4 v[116:119], v14, s[44:47], 0 offen offset:1024
    buffer_load_dwordx4 v[120:123], v14, s[44:47], 0 offen offset:2048
    buffer_load_dwordx4 v[124:127], v14, s[44:47], 0 offen offset:3072
    buffer_load_dwordx4 v[128:131], v15, s[44:47], 0 offen offset:0
    buffer_load_dwordx4 v[132:135], v15, s[44:47], 0 offen offset:1024
    buffer_load_dwordx4 v[136:139], v15, s[44:47], 0 offen offset:2048
    buffer_load_dwordx4 v[140:143], v15, s[44:47], 0 offen offset:3072
    s_add_u32 s82, s82, 0x4000
    buffer_load_dwordx4 v[24:27], v177, s[48:51], s82 offen nt
    buffer_load_dwordx4 v[28:31], v177, s[52:55], s82 offen nt
    s_waitcnt vmcnt(12)
    v_lshlrev_b32 v192, 16, v16
    v_and_b32 v193, 0xffff0000, v16
    v_lshlrev_b32 v196, 16, v20
    v_and_b32 v197, 0xffff0000, v20
    v_lshlrev_b32 v194, 16, v17
    v_and_b32 v195, 0xffff0000, v17
    v_lshlrev_b32 v198, 16, v21
    v_and_b32 v199, 0xffff0000, v21
    v_pk_mul_f32 v[196:197], v[196:197], v[192:193] neg_lo:[1,0] neg_hi:[1,0]
    v_pk_mul_f32 v[198:199], v[198:199], v[194:195] neg_lo:[1,0] neg_hi:[1,0]
    ds_write_b128 v176, v[192:195] offset:0
    ds_write_b128 v176, v[196:199] offset:512
    v_lshlrev_b32 v200, 16, v18
    v_and_b32 v201, 0xffff0000, v18
    v_lshlrev_b32 v204, 16, v22
    v_and_b32 v205, 0xffff0000, v22
    v_lshlrev_b32 v202, 16, v19
    v_and_b32 v203, 0xffff0000, v19
    v_lshlrev_b32 v206, 16, v23
    v_and_b32 v207, 0xffff0000, v23
    v_pk_mul_f32 v[204:205], v[204:205], v[200:201] neg_lo:[1,0] neg_hi:[1,0]
    v_pk_mul_f32 v[206:207], v[206:207], v[202:203] neg_lo:[1,0] neg_hi:[1,0]
    ds_write_b128 v176, v[200:203] offset:16
    ds_write_b128 v176, v[204:207] offset:528
    s_waitcnt vmcnt(10)
    v_lshlrev_b32 v208, 16, v32
    v_lshlrev_b32 v209, 16, v34
    v_and_b32 v210, 0xffff0000, v32
    v_and_b32 v211, 0xffff0000, v34
    v_mul_f32_e64 v209, -v209, v208
    v_mul_f32_e64 v211, -v211, v210
    ds_write_b128 v179, v[208:211] offset:0
    v_lshlrev_b32 v212, 16, v33
    v_lshlrev_b32 v213, 16, v35
    v_and_b32 v214, 0xffff0000, v33
    v_and_b32 v215, 0xffff0000, v35
    v_mul_f32_e64 v213, -v213, v212
    v_mul_f32_e64 v215, -v215, v214
    ds_write_b128 v179, v[212:215] offset:16
    s_waitcnt lgkmcnt(0)
    s_barrier
    s_lshl_b32 s80, s72, 15
    s_add_u32 s64, s30, s80
    s_addc_u32 s65, s31, 0
    s_and_b32 s65, s65, 0xffff
    s_mov_b32 s66, 32768
    s_mov_b32 s67, 0x00020000
    s_lshl_b32 s80, s72, 18
    s_add_u32 s68, s34, s80
    s_addc_u32 s69, s35, 0
    s_and_b32 s69, s69, 0xffff
    s_mov_b32 s70, 140288
    s_mov_b32 s71, 0x00020000
    s_movk_i32 s78, 0x1000
    v_mul_u32_u24 v144, 8704, v10
    v_add_u32 v144, 108608, v144
    v_lshrrev_b32 v14, 4, v11
    v_mul_u32_u24 v14, 272, v14
    v_and_b32 v15, 15, v11
    v_lshl_add_u32 v14, v15, 4, v14
    v_add_u32 v14, v14, v144
    v_mul_u32_u24 v15, 272, v12
    v_lshl_add_u32 v15, v13, 4, v15
    v_add_u32 v15, v15, v144
    v_and_b32 v145, 0x13, v12
    v_and_b32 v146, 4, v12
    v_lshl_or_b32 v145, v146, 1, v145
    v_and_b32 v146, 8, v12
    v_lshrrev_b32 v146, 1, v146
    v_or_b32 v145, v145, v146
    v_mul_u32_u24 v3, 272, v145
    v_lshl_add_u32 v3, v13, 4, v3
    s_lshl_b32 s79, s72, 2
    v_mov_b32 v6, s79
    v_lshrrev_b32 v5, 1, v4
    v_add_u32 v5, 0x20000, v5
    s_lshl_b32 s79, s74, 8
    s_add_u32 s79, s79, 139264
    v_mov_b32 v1, s79
    s_mov_b32 s77, 0x3e0293ee
    v_mov_b32 v8, 0xff61b1e6
    v_mov_b32 v9, 0
    v_mov_b32 v48, 0
    v_mov_b32 v49, 0
    v_mov_b32 v50, 0
    v_mov_b32 v51, 0
    v_mov_b32 v52, 0
    v_mov_b32 v53, 0
    v_mov_b32 v54, 0
    v_mov_b32 v55, 0
    v_mov_b32 v56, 0
    v_mov_b32 v57, 0
    v_mov_b32 v58, 0
    v_mov_b32 v59, 0
    v_mov_b32 v60, 0
    v_mov_b32 v61, 0
    v_mov_b32 v62, 0
    v_mov_b32 v63, 0
    v_mov_b32 v64, 0
    v_mov_b32 v65, 0
    v_mov_b32 v66, 0
    v_mov_b32 v67, 0
    v_mov_b32 v68, 0
    v_mov_b32 v69, 0
    v_mov_b32 v70, 0
    v_mov_b32 v71, 0
    v_mov_b32 v72, 0
    v_mov_b32 v73, 0
    v_mov_b32 v74, 0
    v_mov_b32 v75, 0
    v_mov_b32 v76, 0
    v_mov_b32 v77, 0
    v_mov_b32 v78, 0
    v_mov_b32 v79, 0
    v_mov_b32 v80, 0
    v_mov_b32 v81, 0
    v_mov_b32 v82, 0
    v_mov_b32 v83, 0
    v_mov_b32 v84, 0
    v_mov_b32 v85, 0
    v_mov_b32 v86, 0
    v_mov_b32 v87, 0
    v_mov_b32 v88, 0
    v_mov_b32 v89, 0
    v_mov_b32 v90, 0
    v_mov_b32 v91, 0
    v_mov_b32 v92, 0
    v_mov_b32 v93, 0
    v_mov_b32 v94, 0
    v_mov_b32 v95, 0
    v_mov_b32 v96, 0
    v_mov_b32 v97, 0
    v_mov_b32 v98, 0
    v_mov_b32 v99, 0
    v_mov_b32 v100, 0
    v_mov_b32 v101, 0
    v_mov_b32 v102, 0
    v_mov_b32 v103, 0
    v_mov_b32 v104, 0
    v_mov_b32 v105, 0
    v_mov_b32 v106, 0
    v_mov_b32 v107, 0
    v_mov_b32 v108, 0
    v_mov_b32 v109, 0
    v_mov_b32 v110, 0
    v_mov_b32 v111, 0
    s_mov_b32 s81, 0
    s_lshl_b32 s20, s74, 15
    s_lshl_b32 s21, s74, 11
    s_lshl_b32 s79, 1, s73
    s_xor_b32 s16, s79, 15
    s_lshl_b32 s79, 1, s74
    s_xor_b32 s25, s79, 31
    s_mov_b32 s17, 0
    s_mov_b32 s23, 0
    s_mov_b32 s24, 0
    s_mov_b32 s26, 0
    s_waitcnt vmcnt(9)
    ds_write_b128 v14, v[112:115] offset:0
    s_waitcnt vmcnt(8)
    ds_write_b128 v14, v[116:119] offset:1088
    s_waitcnt vmcnt(7)
    ds_write_b128 v14, v[120:123] offset:2176
    s_waitcnt vmcnt(6)
    ds_write_b128 v14, v[124:127] offset:3264
    s_waitcnt vmcnt(5)
    ds_write_b128 v14, v[128:131] offset:4352
    s_waitcnt vmcnt(4)
    ds_write_b128 v14, v[132:135] offset:5440
    s_waitcnt vmcnt(3)
    ds_write_b128 v14, v[136:139] offset:6528
    s_waitcnt vmcnt(2)
    ds_write_b128 v14, v[140:143] offset:7616
    s_waitcnt lgkmcnt(0)
    ds_read_b128 a[0:3], v15 offset:0
    ds_read_b128 a[4:7], v15 offset:32
    ds_read_b128 a[8:11], v15 offset:64
    ds_read_b128 a[12:15], v15 offset:96
    ds_read_b128 a[16:19], v15 offset:128
    ds_read_b128 a[20:23], v15 offset:160
    ds_read_b128 a[24:27], v15 offset:192
    ds_read_b128 a[28:31], v15 offset:224
    s_waitcnt vmcnt(0)
    v_lshlrev_b32 v192, 16, v24
    v_and_b32 v193, 0xffff0000, v24
    v_lshlrev_b32 v196, 16, v28
    v_and_b32 v197, 0xffff0000, v28
    v_lshlrev_b32 v194, 16, v25
    v_and_b32 v195, 0xffff0000, v25
    v_lshlrev_b32 v198, 16, v29
    v_and_b32 v199, 0xffff0000, v29
    v_pk_mul_f32 v[196:197], v[196:197], v[192:193] neg_lo:[1,0] neg_hi:[1,0]
    v_pk_mul_f32 v[198:199], v[198:199], v[194:195] neg_lo:[1,0] neg_hi:[1,0]
    ds_write_b128 v176, v[192:195] offset:16384
    ds_write_b128 v176, v[196:199] offset:16896
    v_lshlrev_b32 v200, 16, v26
    v_and_b32 v201, 0xffff0000, v26
    v_lshlrev_b32 v204, 16, v30
    v_and_b32 v205, 0xffff0000, v30
    v_lshlrev_b32 v202, 16, v27
    v_and_b32 v203, 0xffff0000, v27
    v_lshlrev_b32 v206, 16, v31
    v_and_b32 v207, 0xffff0000, v31
    v_pk_mul_f32 v[204:205], v[204:205], v[200:201] neg_lo:[1,0] neg_hi:[1,0]
    v_pk_mul_f32 v[206:207], v[206:207], v[202:203] neg_lo:[1,0] neg_hi:[1,0]
    ds_write_b128 v176, v[200:203] offset:16400
    ds_write_b128 v176, v[204:207] offset:16912
    s_waitcnt lgkmcnt(0)
    s_mov_b32 s3, 33792
    v_mov_b32 v182, v4
    s_barrier
L_cloop:
    s_mov_b32 s27, 0
    s_mov_b32 s22, 0
    s_cmp_lt_u32 s76, 2
    s_cbranch_scc1 L_early
    s_cmp_lt_u32 s76, 12
    s_cbranch_scc1 L_noat
    s_cmp_eq_u32 s76, 12
    s_cbranch_scc1 L_ichk
    s_cmp_lg_u32 s76, 15
    s_cbranch_scc1 L_noat
    v_mov_b32 v10, 108544
    ds_read_b32 v11, v10
    s_cmp_eq_u32 s74, s73
    s_cselect_b32 s22, 1, 0
    s_waitcnt lgkmcnt(0)
    v_readfirstlane_b32 s23, v11
    s_branch L_noat
L_ichk:
    s_cmp_lg_u32 s74, 0
    s_cbranch_scc1 L_noat
    s_mov_b32 s27, 1
    s_mov_b64 exec, 1
    global_load_dword v7, v6, s[32:33] sc1
    s_mov_b64 exec, -1
    s_branch L_noat
L_early:
    s_cmp_lg_u32 s74, 0
    s_cbranch_scc1 L_noat
    s_cmp_eq_u32 s76, 0
    s_cbranch_scc0 L_zero
    s_mov_b32 s27, 3
    v_mov_b32 v11, 1
    s_mov_b64 exec, 1
    global_atomic_add v7, v6, v11, s[32:33] sc0
    s_mov_b64 exec, -1
    s_branch L_noat
L_zero:
    s_cmp_eq_u32 s24, 0
    s_cbranch_scc1 L_noat
    s_mov_b32 s27, 4
    v_lshlrev_b32 v10, 4, v4
    v_add_u32 v10, 139264, v10
    v_mov_b32 v11, 0
    s_mov_b64 exec, 15
    buffer_store_dword v11, v10, s[68:71], 0 offen sc1
    s_mov_b64 exec, -1
L_noat:
    s_and_b32 s79, s22, s23
    s_cbranch_scc0 L_np1
    s_mov_b64 exec, 1
    buffer_load_dword v2, v1, s[68:71], 0 offen sc1
    s_mov_b64 exec, -1
L_np1:
    ds_read_b128 v[112:115], v3 offset:0
    ds_read_b128 v[116:119], v3 offset:32
    ds_read_b128 v[120:123], v3 offset:64
    ds_read_b128 v[124:127], v3 offset:96
    ds_read_b128 v[128:131], v3 offset:128
    ds_read_b128 v[132:135], v3 offset:160
    ds_read_b128 v[136:139], v3 offset:192
    ds_read_b128 v[140:143], v3 offset:224
    ds_read_b128 v[144:147], v3 offset:8704
    ds_read_b128 v[148:151], v3 offset:8736
    ds_read_b128 v[152:155], v3 offset:8768
    ds_read_b128 v[156:159], v3 offset:8800
    ds_read_b128 v[160:163], v3 offset:8832
    ds_read_b128 v[164:167], v3 offset:8864
    ds_read_b128 v[168:171], v3 offset:8896
    ds_read_b128 v[172:175], v3 offset:8928
    s_waitcnt lgkmcnt(15)
    v_mfma_f32_32x32x16_bf16 v[16:31], v[112:115], a[0:3], 0
    s_waitcnt lgkmcnt(14)
    v_mfma_f32_32x32x16_bf16 v[16:31], v[116:119], a[4:7], v[16:31]
    s_waitcnt lgkmcnt(13)
    v_mfma_f32_32x32x16_bf16 v[16:31], v[120:123], a[8:11], v[16:31]
    s_waitcnt lgkmcnt(12)
    v_mfma_f32_32x32x16_bf16 v[16:31], v[124:127], a[12:15], v[16:31]
    s_waitcnt lgkmcnt(11)
    v_mfma_f32_32x32x16_bf16 v[16:31], v[128:131], a[16:19], v[16:31]
    s_waitcnt lgkmcnt(10)
    v_mfma_f32_32x32x16_bf16 v[16:31], v[132:135], a[20:23], v[16:31]
    s_waitcnt lgkmcnt(9)
    v_mfma_f32_32x32x16_bf16 v[16:31], v[136:139], a[24:27], v[16:31]
    s_waitcnt lgkmcnt(8)
    v_mfma_f32_32x32x16_bf16 v[16:31], v[140:143], a[28:31], v[16:31]
    s_waitcnt lgkmcnt(7)
    v_mfma_f32_32x32x16_bf16 v[32:47], v[144:147], a[0:3], 0
    s_waitcnt lgkmcnt(6)
    v_mfma_f32_32x32x16_bf16 v[32:47], v[148:151], a[4:7], v[32:47]
    s_waitcnt lgkmcnt(5)
    v_mfma_f32_32x32x16_bf16 v[32:47], v[152:155], a[8:11], v[32:47]
    s_waitcnt lgkmcnt(4)
    v_mfma_f32_32x32x16_bf16 v[32:47], v[156:159], a[12:15], v[32:47]
    s_waitcnt lgkmcnt(3)
    v_mfma_f32_32x32x16_bf16 v[32:47], v[160:163], a[16:19], v[32:47]
    s_waitcnt lgkmcnt(2)
    v_mfma_f32_32x32x16_bf16 v[32:47], v[164:167], a[20:23], v[32:47]
    s_waitcnt lgkmcnt(1)
    v_mfma_f32_32x32x16_bf16 v[32:47], v[168:171], a[24:27], v[32:47]
    s_waitcnt lgkmcnt(0)
    v_mfma_f32_32x32x16_bf16 v[32:47], v[172:175], a[28:31], v[32:47]
    s_nop 4
    v_max3_f32 v10, v16, v17, v18
    v_max3_f32 v10, v10, v19, v20
    v_max3_f32 v10, v10, v21, v22
    v_max3_f32 v10, v10, v23, v24
    v_max3_f32 v10, v10, v25, v26
    v_max3_f32 v10, v10, v27, v28
    v_max3_f32 v10, v10, v29, v30
    v_max3_f32 v10, v10, v31, v32
    v_max3_f32 v10, v10, v33, v34
    v_max3_f32 v10, v10, v35, v36
    v_max3_f32 v10, v10, v37, v38
    v_max3_f32 v10, v10, v39, v40
    v_max3_f32 v10, v10, v41, v42
    v_max3_f32 v10, v10, v43, v44
    v_max3_f32 v10, v10, v45, v46
    v_max_f32 v10, v10, v47
    v_mov_b32 v11, v10
    s_nop 1
    v_permlane32_swap_b32 v10, v11
    s_nop 1
    v_max_f32 v10, v10, v11
    v_mul_f32 v10, s77, v10
    v_max_f32 v11, v8, v10
    v_sub_f32 v12, v8, v11
    v_exp_f32 v12, v12
    v_mov_b32 v8, v11
    v_fma_f32 v16, v16, s77, -v8
    v_fma_f32 v17, v17, s77, -v8
    v_fma_f32 v18, v18, s77, -v8
    v_fma_f32 v19, v19, s77, -v8
    v_fma_f32 v20, v20, s77, -v8
    v_fma_f32 v21, v21, s77, -v8
    v_fma_f32 v22, v22, s77, -v8
    v_fma_f32 v23, v23, s77, -v8
    v_fma_f32 v24, v24, s77, -v8
    v_fma_f32 v25, v25, s77, -v8
    v_fma_f32 v26, v26, s77, -v8
    v_fma_f32 v27, v27, s77, -v8
    v_fma_f32 v28, v28, s77, -v8
    v_fma_f32 v29, v29, s77, -v8
    v_fma_f32 v30, v30, s77, -v8
    v_fma_f32 v31, v31, s77, -v8
    v_fma_f32 v32, v32, s77, -v8
    v_fma_f32 v33, v33, s77, -v8
    v_fma_f32 v34, v34, s77, -v8
    v_fma_f32 v35, v35, s77, -v8
    v_fma_f32 v36, v36, s77, -v8
    v_fma_f32 v37, v37, s77, -v8
    v_fma_f32 v38, v38, s77, -v8
    v_fma_f32 v39, v39, s77, -v8
    v_fma_f32 v40, v40, s77, -v8
    v_fma_f32 v41, v41, s77, -v8
    v_fma_f32 v42, v42, s77, -v8
    v_fma_f32 v43, v43, s77, -v8
    v_fma_f32 v44, v44, s77, -v8
    v_fma_f32 v45, v45, s77, -v8
    v_fma_f32 v46, v46, s77, -v8
    v_fma_f32 v47, v47, s77, -v8
    v_mul_f32 v9, v9, v12
    v_exp_f32 v16, v16
    v_exp_f32 v17, v17
    v_exp_f32 v18, v18
    v_exp_f32 v19, v19
    v_exp_f32 v20, v20
    v_exp_f32 v21, v21
    v_exp_f32 v22, v22
    v_exp_f32 v23, v23
    v_exp_f32 v24, v24
    v_exp_f32 v25, v25
    v_exp_f32 v26, v26
    v_exp_f32 v27, v27
    v_exp_f32 v28, v28
    v_exp_f32 v29, v29
    v_exp_f32 v30, v30
    v_exp_f32 v31, v31
    v_exp_f32 v32, v32
    v_exp_f32 v33, v33
    v_exp_f32 v34, v34
    v_exp_f32 v35, v35
    v_exp_f32 v36, v36
    v_exp_f32 v37, v37
    v_exp_f32 v38, v38
    v_exp_f32 v39, v39
    v_exp_f32 v40, v40
    v_exp_f32 v41, v41
    v_exp_f32 v42, v42
    v_exp_f32 v43, v43
    v_exp_f32 v44, v44
    v_exp_f32 v45, v45
    v_exp_f32 v46, v46
    v_exp_f32 v47, v47
    v_pk_mul_f32 v[48:49], v[48:49], v[12:13] op_sel_hi:[1,0]
    v_pk_mul_f32 v[50:51], v[50:51], v[12:13] op_sel_hi:[1,0]
    v_pk_mul_f32 v[52:53], v[52:53], v[12:13] op_sel_hi:[1,0]
    v_pk_mul_f32 v[54:55], v[54:55], v[12:13] op_sel_hi:[1,0]
    v_pk_mul_f32 v[56:57], v[56:57], v[12:13] op_sel_hi:[1,0]
    v_pk_mul_f32 v[58:59], v[58:59], v[12:13] op_sel_hi:[1,0]
    v_pk_mul_f32 v[60:61], v[60:61], v[12:13] op_sel_hi:[1,0]
    v_pk_mul_f32 v[62:63], v[62:63], v[12:13] op_sel_hi:[1,0]
    v_pk_mul_f32 v[64:65], v[64:65], v[12:13] op_sel_hi:[1,0]
    v_pk_mul_f32 v[66:67], v[66:67], v[12:13] op_sel_hi:[1,0]
    v_pk_mul_f32 v[68:69], v[68:69], v[12:13] op_sel_hi:[1,0]
    v_pk_mul_f32 v[70:71], v[70:71], v[12:13] op_sel_hi:[1,0]
    v_pk_mul_f32 v[72:73], v[72:73], v[12:13] op_sel_hi:[1,0]
    v_pk_mul_f32 v[74:75], v[74:75], v[12:13] op_sel_hi:[1,0]
    v_pk_mul_f32 v[76:77], v[76:77], v[12:13] op_sel_hi:[1,0]
    v_pk_mul_f32 v[78:79], v[78:79], v[12:13] op_sel_hi:[1,0]
    v_pk_mul_f32 v[80:81], v[80:81], v[12:13] op_sel_hi:[1,0]
    v_pk_mul_f32 v[82:83], v[82:83], v[12:13] op_sel_hi:[1,0]
    v_pk_mul_f32 v[84:85], v[84:85], v[12:13] op_sel_hi:[1,0]
    v_pk_mul_f32 v[86:87], v[86:87], v[12:13] op_sel_hi:[1,0]
    v_pk_mul_f32 v[88:89], v[88:89], v[12:13] op_sel_hi:[1,0]
    v_pk_mul_f32 v[90:91], v[90:91], v[12:13] op_sel_hi:[1,0]
    v_pk_mul_f32 v[92:93], v[92:93], v[12:13] op_sel_hi:[1,0]
    v_pk_mul_f32 v[94:95], v[94:95], v[12:13] op_sel_hi:[1,0]
    v_pk_mul_f32 v[96:97], v[96:97], v[12:13] op_sel_hi:[1,0]
    v_pk_mul_f32 v[98:99], v[98:99], v[12:13] op_sel_hi:[1,0]
    v_pk_mul_f32 v[100:101], v[100:101], v[12:13] op_sel_hi:[1,0]
    v_pk_mul_f32 v[102:103], v[102:103], v[12:13] op_sel_hi:[1,0]
    v_pk_mul_f32 v[104:105], v[104:105], v[12:13] op_sel_hi:[1,0]
    v_pk_mul_f32 v[106:107], v[106:107], v[12:13] op_sel_hi:[1,0]
    v_pk_mul_f32 v[108:109], v[108:109], v[12:13] op_sel_hi:[1,0]
    v_pk_mul_f32 v[110:111], v[110:111], v[12:13] op_sel_hi:[1,0]
    v_pk_add_f32 v[10:11], v[16:17], v[18:19]
    v_pk_add_f32 v[14:15], v[20:21], v[22:23]
    v_pk_add_f32 v[10:11], v[10:11], v[24:25]
    v_pk_add_f32 v[14:15], v[14:15], v[26:27]
    v_pk_add_f32 v[10:11], v[10:11], v[28:29]
    v_pk_add_f32 v[14:15], v[14:15], v[30:31]
    v_pk_add_f32 v[10:11], v[10:11], v[32:33]
    v_pk_add_f32 v[14:15], v[14:15], v[34:35]
    v_pk_add_f32 v[10:11], v[10:11], v[36:37]
    v_pk_add_f32 v[14:15], v[14:15], v[38:39]
    v_pk_add_f32 v[10:11], v[10:11], v[40:41]
    v_pk_add_f32 v[14:15], v[14:15], v[42:43]
    v_pk_add_f32 v[10:11], v[10:11], v[44:45]
    v_pk_add_f32 v[14:15], v[14:15], v[46:47]
    v_pk_add_f32 v[10:11], v[10:11], v[14:15]
    v_cvt_pk_bf16_f32 v16, v16, v17
    v_cvt_pk_bf16_f32 v17, v18, v19
    v_cvt_pk_bf16_f32 v18, v20, v21
    v_cvt_pk_bf16_f32 v19, v22, v23
    v_cvt_pk_bf16_f32 v20, v24, v25
    v_cvt_pk_bf16_f32 v21, v26, v27
    v_cvt_pk_bf16_f32 v22, v28, v29
    v_cvt_pk_bf16_f32 v23, v30, v31
    v_cvt_pk_bf16_f32 v24, v32, v33
    v_cvt_pk_bf16_f32 v25, v34, v35
    v_cvt_pk_bf16_f32 v26, v36, v37
    v_cvt_pk_bf16_f32 v27, v38, v39
    v_cvt_pk_bf16_f32 v28, v40, v41
    v_cvt_pk_bf16_f32 v29, v42, v43
    v_cvt_pk_bf16_f32 v30, v44, v45
    v_cvt_pk_bf16_f32 v31, v46, v47
    v_add_f32 v9, v9, v10
    v_add_f32 v9, v9, v11
    s_cmp_lg_u32 s27, 0
    s_cbranch_scc1 L_w0svc
    s_cmp_lg_u32 s76, 15
    s_cbranch_scc1 L_notid
    s_and_b32 s79, s22, s23
    s_cbranch_scc0 L_ne
    s_waitcnt vmcnt(0)
    v_readfirstlane_b32 s19, v2
    s_and_b32 s19, s19, s16
    s_cmp_eq_u32 s19, 0
    s_cbranch_scc1 L_notid
    s_ff1_i32_b32 s82, s19
    s_lshl_b32 s79, s82, 9
    s_add_u32 s79, s79, s21
    s_lshl_b32 s80, s82, 13
    s_add_u32 s80, s80, s20
    buffer_load_dwordx2 v[176:177], v5, s[68:71], s79 offen sc1
    buffer_load_dwordx4 v[192:195], v4, s[68:71], s80 offen offset:0 sc1
    buffer_load_dwordx4 v[196:199], v4, s[68:71], s80 offen offset:1024 sc1
    buffer_load_dwordx4 v[200:203], v4, s[68:71], s80 offen offset:2048 sc1
    buffer_load_dwordx4 v[204:207], v4, s[68:71], s80 offen offset:3072 sc1
    s_add_u32 s80, s80, 0x1000
    buffer_load_dwordx4 v[208:211], v4, s[68:71], s80 offen offset:0 sc1
    buffer_load_dwordx4 v[212:215], v4, s[68:71], s80 offen offset:1024 sc1
    buffer_load_dwordx4 v[216:219], v4, s[68:71], s80 offen offset:2048 sc1
    buffer_load_dwordx4 v[220:223], v4, s[68:71], s80 offen offset:3072 sc1
    s_bitset0_b32 s16, s82
    s_bitset0_b32 s19, s82
    s_add_u32 s17, s17, 1
    s_cmp_eq_u32 s19, 0
    s_cbranch_scc1 L_notid
    s_ff1_i32_b32 s82, s19
    s_lshl_b32 s79, s82, 9
    s_add_u32 s79, s79, s21
    s_lshl_b32 s80, s82, 13
    s_add_u32 s80, s80, s20
    buffer_load_dwordx2 v[178:179], v5, s[68:71], s79 offen sc1
    buffer_load_dwordx4 a[0:3], v4, s[68:71], s80 offen offset:0 sc1
    buffer_load_dwordx4 a[4:7], v4, s[68:71], s80 offen offset:1024 sc1
    buffer_load_dwordx4 a[8:11], v4, s[68:71], s80 offen offset:2048 sc1
    buffer_load_dwordx4 a[12:15], v4, s[68:71], s80 offen offset:3072 sc1
    s_add_u32 s80, s80, 0x1000
    buffer_load_dwordx4 a[16:19], v4, s[68:71], s80 offen offset:0 sc1
    buffer_load_dwordx4 a[20:23], v4, s[68:71], s80 offen offset:1024 sc1
    buffer_load_dwordx4 a[24:27], v4, s[68:71], s80 offen offset:2048 sc1
    buffer_load_dwordx4 a[28:31], v4, s[68:71], s80 offen offset:3072 sc1
    s_bitset0_b32 s16, s82
    s_bitset0_b32 s19, s82
    s_add_u32 s17, s17, 1
    s_branch L_notid
L_ne:
    s_cmp_lg_u32 s74, 0
    s_cbranch_scc1 L_notid
    s_mov_b32 s80, 0
L_iwait:
    s_cmp_lg_u32 s23, 0
    s_cbranch_scc1 L_notid
    s_cmp_ge_u32 s80, 20000
    s_cbranch_scc1 L_notid
    s_add_u32 s80, s80, 1
    s_mov_b64 exec, 1
    global_load_dword v7, v6, s[32:33] sc1
    s_mov_b64 exec, -1
    s_waitcnt vmcnt(0)
    v_readfirstlane_b32 s83, v7
    s_bfe_u32 s23, s83, 0x10004
    s_branch L_iwait
L_w0svc:
    s_waitcnt vmcnt(0)
    s_cmp_eq_u32 s27, 4
    s_cbranch_scc1 L_w0m4
    v_readfirstlane_b32 s83, v7
    s_cmp_eq_u32 s27, 3
    s_cbranch_scc1 L_w0m3
    s_bfe_u32 s79, s83, 0x10004
    v_mov_b32 v10, s79
    v_mov_b32 v11, 108544
    ds_write_b32 v11, v10
    s_waitcnt lgkmcnt(0)
    s_branch L_notid
L_w0m3:
    s_and_b32 s79, s83, 7
    s_cmp_eq_u32 s79, 0
    s_cselect_b32 s24, 1, 0
    s_branch L_notid
L_w0m4:
    v_mov_b32 v11, 16
    s_mov_b64 exec, 1
    global_atomic_add v6, v11, s[32:33]
    s_mov_b64 exec, -1
L_notid:
    s_barrier
    s_cmp_eq_u32 s22, 0
    s_cbranch_scc1 L_np2
    s_mov_b64 exec, 1
    buffer_load_dword v2, v1, s[68:71], 0 offen sc1
    s_mov_b64 exec, -1
L_np2:
    ds_read_b128 v[112:115], v182 offset:17408
    ds_read_b128 v[116:119], v182 offset:18432
    ds_read_b128 v[120:123], v182 offset:19456
    ds_read_b128 v[124:127], v182 offset:20480
    ds_read_b128 v[128:131], v182 offset:21504
    ds_read_b128 v[132:135], v182 offset:22528
    ds_read_b128 v[136:139], v182 offset:23552
    ds_read_b128 v[140:143], v182 offset:24576
    ds_read_b128 v[144:147], v182 offset:25600
    ds_read_b128 v[148:151], v182 offset:26624
    ds_read_b128 v[152:155], v182 offset:27648
    ds_read_b128 v[156:159], v182 offset:28672
    ds_read_b128 v[160:163], v182 offset:29696
    ds_read_b128 v[164:167], v182 offset:30720
    ds_read_b128 v[168:171], v182 offset:31744
    ds_read_b128 v[172:175], v182 offset:32768
    s_waitcnt lgkmcnt(15)
    v_mfma_f32_32x32x16_bf16 v[48:63], v[112:115], v[16:19], v[48:63]
    s_waitcnt lgkmcnt(14)
    v_mfma_f32_32x32x16_bf16 v[64:79], v[116:119], v[16:19], v[64:79]
    s_waitcnt lgkmcnt(13)
    v_mfma_f32_32x32x16_bf16 v[80:95], v[120:123], v[16:19], v[80:95]
    s_waitcnt lgkmcnt(12)
    v_mfma_f32_32x32x16_bf16 v[96:111], v[124:127], v[16:19], v[96:111]
    s_waitcnt lgkmcnt(11)
    v_mfma_f32_32x32x16_bf16 v[48:63], v[128:131], v[20:23], v[48:63]
    s_waitcnt lgkmcnt(10)
    v_mfma_f32_32x32x16_bf16 v[64:79], v[132:135], v[20:23], v[64:79]
    s_waitcnt lgkmcnt(9)
    v_mfma_f32_32x32x16_bf16 v[80:95], v[136:139], v[20:23], v[80:95]
    s_waitcnt lgkmcnt(8)
    v_mfma_f32_32x32x16_bf16 v[96:111], v[140:143], v[20:23], v[96:111]
    s_waitcnt lgkmcnt(7)
    v_mfma_f32_32x32x16_bf16 v[48:63], v[144:147], v[24:27], v[48:63]
    s_waitcnt lgkmcnt(6)
    v_mfma_f32_32x32x16_bf16 v[64:79], v[148:151], v[24:27], v[64:79]
    s_waitcnt lgkmcnt(5)
    v_mfma_f32_32x32x16_bf16 v[80:95], v[152:155], v[24:27], v[80:95]
    s_waitcnt lgkmcnt(4)
    v_mfma_f32_32x32x16_bf16 v[96:111], v[156:159], v[24:27], v[96:111]
    s_waitcnt lgkmcnt(3)
    v_mfma_f32_32x32x16_bf16 v[48:63], v[160:163], v[28:31], v[48:63]
    s_waitcnt lgkmcnt(2)
    v_mfma_f32_32x32x16_bf16 v[64:79], v[164:167], v[28:31], v[64:79]
    s_waitcnt lgkmcnt(1)
    v_mfma_f32_32x32x16_bf16 v[80:95], v[168:171], v[28:31], v[80:95]
    s_waitcnt lgkmcnt(0)
    v_mfma_f32_32x32x16_bf16 v[96:111], v[172:175], v[28:31], v[96:111]
    v_add_u32 v3, s3, v3
    v_add_u32 v182, s3, v182
    s_sub_u32 s3, 0, s3
    s_add_u32 s76, s76, 1
    s_cmp_lt_u32 s76, 16
    s_cbranch_scc1 L_cloop
    v_mov_b32 v11, v9
    s_cmp_eq_u32 s74, s73
    s_nop 0
    v_permlane32_swap_b32 v9, v11
    s_nop 1
    v_add_f32 v9, v9, v11
    s_cbranch_scc1 L_owner
L_publish:
    s_lshl_b32 s80, s73, 13
    s_add_u32 s80, s80, s20
    v_add_u32 v13, s80, v4
    s_lshl_b32 s80, s73, 9
    s_add_u32 s80, s80, s21
    s_nop 1
    buffer_store_dwordx2 v[8:9], v5, s[68:71], s80 offen sc1
    v_cvt_pk_bf16_f32 v112, v48, v64
    v_cvt_pk_bf16_f32 v113, v80, v96
    v_cvt_pk_bf16_f32 v114, v49, v65
    v_cvt_pk_bf16_f32 v115, v81, v97
    v_cvt_pk_bf16_f32 v116, v50, v66
    v_cvt_pk_bf16_f32 v117, v82, v98
    v_cvt_pk_bf16_f32 v118, v51, v67
    v_cvt_pk_bf16_f32 v119, v83, v99
    buffer_store_dwordx4 v[112:115], v13, s[68:71], 0 offen offset:0 sc1
    buffer_store_dwordx4 v[116:119], v13, s[68:71], 0 offen offset:1024 sc1
    v_cvt_pk_bf16_f32 v120, v52, v68
    v_cvt_pk_bf16_f32 v121, v84, v100
    v_cvt_pk_bf16_f32 v122, v53, v69
    v_cvt_pk_bf16_f32 v123, v85, v101
    v_cvt_pk_bf16_f32 v124, v54, v70
    v_cvt_pk_bf16_f32 v125, v86, v102
    v_cvt_pk_bf16_f32 v126, v55, v71
    v_cvt_pk_bf16_f32 v127, v87, v103
    buffer_store_dwordx4 v[120:123], v13, s[68:71], 0 offen offset:2048 sc1
    buffer_store_dwordx4 v[124:127], v13, s[68:71], 0 offen offset:3072 sc1
    v_cvt_pk_bf16_f32 v128, v56, v72
    v_cvt_pk_bf16_f32 v129, v88, v104
    v_cvt_pk_bf16_f32 v130, v57, v73
    v_cvt_pk_bf16_f32 v131, v89, v105
    v_cvt_pk_bf16_f32 v132, v58, v74
    v_cvt_pk_bf16_f32 v133, v90, v106
    v_cvt_pk_bf16_f32 v134, v59, v75
    v_cvt_pk_bf16_f32 v135, v91, v107
    buffer_store_dwordx4 v[128:131], v13, s[68:71], s78 offen offset:0 sc1
    buffer_store_dwordx4 v[132:135], v13, s[68:71], s78 offen offset:1024 sc1
    v_cvt_pk_bf16_f32 v136, v60, v76
    v_cvt_pk_bf16_f32 v137, v92, v108
    v_cvt_pk_bf16_f32 v138, v61, v77
    v_cvt_pk_bf16_f32 v139, v93, v109
    v_cvt_pk_bf16_f32 v140, v62, v78
    v_cvt_pk_bf16_f32 v141, v94, v110
    v_cvt_pk_bf16_f32 v142, v63, v79
    v_cvt_pk_bf16_f32 v143, v95, v111
    buffer_store_dwordx4 v[136:139], v13, s[68:71], s78 offen offset:2048 sc1
    buffer_store_dwordx4 v[140:143], v13, s[68:71], s78 offen offset:3072 sc1
    s_lshl_b32 s79, 1, s73
    s_cmp_lg_u32 s26, 0
    s_cselect_b32 s79, 16, s79
    v_mov_b32 v2, s79
    s_waitcnt vmcnt(0)
    s_mov_b64 exec, 1
    buffer_atomic_add v2, v1, s[68:71], 0 offen sc0
    s_mov_b64 exec, -1
    s_waitcnt vmcnt(0)
    v_readfirstlane_b32 s83, v2
    s_or_b32 s83, s83, s79
    s_and_b32 s83, s83, s25
    s_cmp_lg_u32 s83, s25
    s_cbranch_scc1 L_fin
    s_mov_b32 s19, s16
    s_branch L_take
L_owner:
    s_mov_b32 s81, 3
    s_mov_b32 s76, 0
L_poll:
    s_waitcnt vmcnt(0)
    v_readfirstlane_b32 s19, v2
    s_and_b32 s19, s19, s16
L_take:
    s_cmp_eq_u32 s19, 0
    s_cbranch_scc1 L_taken
    s_ff1_i32_b32 s82, s19
    s_cmp_eq_u32 s17, 1
    s_cbranch_scc1 L_take1
    s_cmp_eq_u32 s17, 2
    s_cbranch_scc1 L_take2
    s_lshl_b32 s79, s82, 9
    s_add_u32 s79, s79, s21
    s_lshl_b32 s80, s82, 13
    s_add_u32 s80, s80, s20
    buffer_load_dwordx2 v[176:177], v5, s[68:71], s79 offen sc1
    buffer_load_dwordx4 v[192:195], v4, s[68:71], s80 offen offset:0 sc1
    buffer_load_dwordx4 v[196:199], v4, s[68:71], s80 offen offset:1024 sc1
    buffer_load_dwordx4 v[200:203], v4, s[68:71], s80 offen offset:2048 sc1
    buffer_load_dwordx4 v[204:207], v4, s[68:71], s80 offen offset:3072 sc1
    s_add_u32 s80, s80, 0x1000
    buffer_load_dwordx4 v[208:211], v4, s[68:71], s80 offen offset:0 sc1
    buffer_load_dwordx4 v[212:215], v4, s[68:71], s80 offen offset:1024 sc1
    buffer_load_dwordx4 v[216:219], v4, s[68:71], s80 offen offset:2048 sc1
    buffer_load_dwordx4 v[220:223], v4, s[68:71], s80 offen offset:3072 sc1
    s_bitset0_b32 s16, s82
    s_bitset0_b32 s19, s82
    s_add_u32 s17, s17, 1
    s_branch L_take
L_take1:
    s_lshl_b32 s79, s82, 9
    s_add_u32 s79, s79, s21
    s_lshl_b32 s80, s82, 13
    s_add_u32 s80, s80, s20
    buffer_load_dwordx2 v[178:179], v5, s[68:71], s79 offen sc1
    buffer_load_dwordx4 a[0:3], v4, s[68:71], s80 offen offset:0 sc1
    buffer_load_dwordx4 a[4:7], v4, s[68:71], s80 offen offset:1024 sc1
    buffer_load_dwordx4 a[8:11], v4, s[68:71], s80 offen offset:2048 sc1
    buffer_load_dwordx4 a[12:15], v4, s[68:71], s80 offen offset:3072 sc1
    s_add_u32 s80, s80, 0x1000
    buffer_load_dwordx4 a[16:19], v4, s[68:71], s80 offen offset:0 sc1
    buffer_load_dwordx4 a[20:23], v4, s[68:71], s80 offen offset:1024 sc1
    buffer_load_dwordx4 a[24:27], v4, s[68:71], s80 offen offset:2048 sc1
    buffer_load_dwordx4 a[28:31], v4, s[68:71], s80 offen offset:3072 sc1
    s_bitset0_b32 s16, s82
    s_bitset0_b32 s19, s82
    s_add_u32 s17, s17, 1
    s_branch L_take
L_take2:
    s_lshl_b32 s79, s82, 9
    s_add_u32 s79, s79, s21
    s_lshl_b32 s80, s82, 13
    s_add_u32 s80, s80, s20
    buffer_load_dwordx2 v[180:181], v5, s[68:71], s79 offen sc1
    buffer_load_dwordx4 v[112:115], v4, s[68:71], s80 offen offset:0 sc1
    buffer_load_dwordx4 v[116:119], v4, s[68:71], s80 offen offset:1024 sc1
    buffer_load_dwordx4 v[120:123], v4, s[68:71], s80 offen offset:2048 sc1
    buffer_load_dwordx4 v[124:127], v4, s[68:71], s80 offen offset:3072 sc1
    s_add_u32 s80, s80, 0x1000
    buffer_load_dwordx4 v[128:131], v4, s[68:71], s80 offen offset:0 sc1
    buffer_load_dwordx4 v[132:135], v4, s[68:71], s80 offen offset:1024 sc1
    buffer_load_dwordx4 v[136:139], v4, s[68:71], s80 offen offset:2048 sc1
    buffer_load_dwordx4 v[140:143], v4, s[68:71], s80 offen offset:3072 sc1
    s_bitset0_b32 s16, s82
    s_bitset0_b32 s19, s82
    s_add_u32 s17, s17, 1
    s_branch L_merge
L_taken:
    s_mov_b32 s26, 1
    s_cmp_ge_u32 s76, 3000
    s_cbranch_scc1 L_publish
    s_mov_b32 s26, 0
    s_cmp_eq_u32 s76, 0
    s_cbranch_scc1 L_poll1
    s_sleep 1
L_poll1:
    s_add_u32 s76, s76, 1
    s_mov_b64 exec, 1
    buffer_load_dword v2, v1, s[68:71], 0 offen sc1
    s_mov_b64 exec, -1
    s_branch L_poll
L_merge:
    v_and_b32 v10, 31, v0
    v_bfe_u32 v11, v0, 5, 1
    v_lshlrev_b32 v15, 8, v10
    v_lshl_add_u32 v15, v11, 5, v15
    s_lshl_b32 s82, s74, 13
    s_waitcnt vmcnt(17)
    v_max3_f32 v13, v176, v178, v8
    v_sub_f32 v176, v176, v13
    v_sub_f32 v178, v178, v13
    v_sub_f32 v8, v8, v13
    v_exp_f32 v176, v176
    v_exp_f32 v178, v178
    v_exp_f32 v8, v8
    s_nop 0
    v_mul_f32 v9, v8, v9
    v_fmac_f32 v9, v176, v177
    v_fmac_f32 v9, v178, v179
    v_pk_mul_f32 v[48:49], v[48:49], v[8:9] op_sel_hi:[1,0]
    v_pk_mul_f32 v[50:51], v[50:51], v[8:9] op_sel_hi:[1,0]
    v_pk_mul_f32 v[52:53], v[52:53], v[8:9] op_sel_hi:[1,0]
    v_pk_mul_f32 v[54:55], v[54:55], v[8:9] op_sel_hi:[1,0]
    v_pk_mul_f32 v[56:57], v[56:57], v[8:9] op_sel_hi:[1,0]
    v_pk_mul_f32 v[58:59], v[58:59], v[8:9] op_sel_hi:[1,0]
    v_pk_mul_f32 v[60:61], v[60:61], v[8:9] op_sel_hi:[1,0]
    v_pk_mul_f32 v[62:63], v[62:63], v[8:9] op_sel_hi:[1,0]
    v_pk_mul_f32 v[64:65], v[64:65], v[8:9] op_sel_hi:[1,0]
    v_pk_mul_f32 v[66:67], v[66:67], v[8:9] op_sel_hi:[1,0]
    v_pk_mul_f32 v[68:69], v[68:69], v[8:9] op_sel_hi:[1,0]
    v_pk_mul_f32 v[70:71], v[70:71], v[8:9] op_sel_hi:[1,0]
    v_pk_mul_f32 v[72:73], v[72:73], v[8:9] op_sel_hi:[1,0]
    v_pk_mul_f32 v[74:75], v[74:75], v[8:9] op_sel_hi:[1,0]
    v_pk_mul_f32 v[76:77], v[76:77], v[8:9] op_sel_hi:[1,0]
    v_pk_mul_f32 v[78:79], v[78:79], v[8:9] op_sel_hi:[1,0]
    v_pk_mul_f32 v[80:81], v[80:81], v[8:9] op_sel_hi:[1,0]
    v_pk_mul_f32 v[82:83], v[82:83], v[8:9] op_sel_hi:[1,0]
    v_pk_mul_f32 v[84:85], v[84:85], v[8:9] op_sel_hi:[1,0]
    v_pk_mul_f32 v[86:87], v[86:87], v[8:9] op_sel_hi:[1,0]
    v_pk_mul_f32 v[88:89], v[88:89], v[8:9] op_sel_hi:[1,0]
    v_pk_mul_f32 v[90:91], v[90:91], v[8:9] op_sel_hi:[1,0]
    v_pk_mul_f32 v[92:93], v[92:93], v[8:9] op_sel_hi:[1,0]
    v_pk_mul_f32 v[94:95], v[94:95], v[8:9] op_sel_hi:[1,0]
    v_pk_mul_f32 v[96:97], v[96:97], v[8:9] op_sel_hi:[1,0]
    v_pk_mul_f32 v[98:99], v[98:99], v[8:9] op_sel_hi:[1,0]
    v_pk_mul_f32 v[100:101], v[100:101], v[8:9] op_sel_hi:[1,0]
    v_pk_mul_f32 v[102:103], v[102:103], v[8:9] op_sel_hi:[1,0]
    v_pk_mul_f32 v[104:105], v[104:105], v[8:9] op_sel_hi:[1,0]
    v_pk_mul_f32 v[106:107], v[106:107], v[8:9] op_sel_hi:[1,0]
    v_pk_mul_f32 v[108:109], v[108:109], v[8:9] op_sel_hi:[1,0]
    v_pk_mul_f32 v[110:111], v[110:111], v[8:9] op_sel_hi:[1,0]
    v_lshlrev_b32 v10, 16, v192
    v_and_b32 v11, 0xffff0000, v192
    v_fmac_f32 v48, v176, v10
    v_fmac_f32 v64, v176, v11
    v_lshlrev_b32 v10, 16, v193
    v_and_b32 v11, 0xffff0000, v193
    v_fmac_f32 v80, v176, v10
    v_fmac_f32 v96, v176, v11
    v_lshlrev_b32 v10, 16, v194
    v_and_b32 v11, 0xffff0000, v194
    v_fmac_f32 v49, v176, v10
    v_fmac_f32 v65, v176, v11
    v_lshlrev_b32 v10, 16, v195
    v_and_b32 v11, 0xffff0000, v195
    v_fmac_f32 v81, v176, v10
    v_fmac_f32 v97, v176, v11
    v_lshlrev_b32 v10, 16, v196
    v_and_b32 v11, 0xffff0000, v196
    v_fmac_f32 v50, v176, v10
    v_fmac_f32 v66, v176, v11
    v_lshlrev_b32 v10, 16, v197
    v_and_b32 v11, 0xffff0000, v197
    v_fmac_f32 v82, v176, v10
    v_fmac_f32 v98, v176, v11
    v_lshlrev_b32 v10, 16, v198
    v_and_b32 v11, 0xffff0000, v198
    v_fmac_f32 v51, v176, v10
    v_fmac_f32 v67, v176, v11
    v_lshlrev_b32 v10, 16, v199
    v_and_b32 v11, 0xffff0000, v199
    v_fmac_f32 v83, v176, v10
    v_fmac_f32 v99, v176, v11
    v_lshlrev_b32 v10, 16, v200
    v_and_b32 v11, 0xffff0000, v200
    v_fmac_f32 v52, v176, v10
    v_fmac_f32 v68, v176, v11
    v_lshlrev_b32 v10, 16, v201
    v_and_b32 v11, 0xffff0000, v201
    v_fmac_f32 v84, v176, v10
    v_fmac_f32 v100, v176, v11
    v_lshlrev_b32 v10, 16, v202
    v_and_b32 v11, 0xffff0000, v202
    v_fmac_f32 v53, v176, v10
    v_fmac_f32 v69, v176, v11
    v_lshlrev_b32 v10, 16, v203
    v_and_b32 v11, 0xffff0000, v203
    v_fmac_f32 v85, v176, v10
    v_fmac_f32 v101, v176, v11
    v_lshlrev_b32 v10, 16, v204
    v_and_b32 v11, 0xffff0000, v204
    v_fmac_f32 v54, v176, v10
    v_fmac_f32 v70, v176, v11
    v_lshlrev_b32 v10, 16, v205
    v_and_b32 v11, 0xffff0000, v205
    v_fmac_f32 v86, v176, v10
    v_fmac_f32 v102, v176, v11
    v_lshlrev_b32 v10, 16, v206
    v_and_b32 v11, 0xffff0000, v206
    v_fmac_f32 v55, v176, v10
    v_fmac_f32 v71, v176, v11
    v_lshlrev_b32 v10, 16, v207
    v_and_b32 v11, 0xffff0000, v207
    v_fmac_f32 v87, v176, v10
    v_fmac_f32 v103, v176, v11
    v_lshlrev_b32 v10, 16, v208
    v_and_b32 v11, 0xffff0000, v208
    v_fmac_f32 v56, v176, v10
    v_fmac_f32 v72, v176, v11
    v_lshlrev_b32 v10, 16, v209
    v_and_b32 v11, 0xffff0000, v209
    v_fmac_f32 v88, v176, v10
    v_fmac_f32 v104, v176, v11
    v_lshlrev_b32 v10, 16, v210
    v_and_b32 v11, 0xffff0000, v210
    v_fmac_f32 v57, v176, v10
    v_fmac_f32 v73, v176, v11
    v_lshlrev_b32 v10, 16, v211
    v_and_b32 v11, 0xffff0000, v211
    v_fmac_f32 v89, v176, v10
    v_fmac_f32 v105, v176, v11
    v_lshlrev_b32 v10, 16, v212
    v_and_b32 v11, 0xffff0000, v212
    v_fmac_f32 v58, v176, v10
    v_fmac_f32 v74, v176, v11
    v_lshlrev_b32 v10, 16, v213
    v_and_b32 v11, 0xffff0000, v213
    v_fmac_f32 v90, v176, v10
    v_fmac_f32 v106, v176, v11
    v_lshlrev_b32 v10, 16, v214
    v_and_b32 v11, 0xffff0000, v214
    v_fmac_f32 v59, v176, v10
    v_fmac_f32 v75, v176, v11
    v_lshlrev_b32 v10, 16, v215
    v_and_b32 v11, 0xffff0000, v215
    v_fmac_f32 v91, v176, v10
    v_fmac_f32 v107, v176, v11
    v_lshlrev_b32 v10, 16, v216
    v_and_b32 v11, 0xffff0000, v216
    v_fmac_f32 v60, v176, v10
    v_fmac_f32 v76, v176, v11
    v_lshlrev_b32 v10, 16, v217
    v_and_b32 v11, 0xffff0000, v217
    v_fmac_f32 v92, v176, v10
    v_fmac_f32 v108, v176, v11
    v_lshlrev_b32 v10, 16, v218
    v_and_b32 v11, 0xffff0000, v218
    v_fmac_f32 v61, v176, v10
    v_fmac_f32 v77, v176, v11
    v_lshlrev_b32 v10, 16, v219
    v_and_b32 v11, 0xffff0000, v219
    v_fmac_f32 v93, v176, v10
    v_fmac_f32 v109, v176, v11
    v_lshlrev_b32 v10, 16, v220
    v_and_b32 v11, 0xffff0000, v220
    v_fmac_f32 v62, v176, v10
    v_fmac_f32 v78, v176, v11
    v_lshlrev_b32 v10, 16, v221
    v_and_b32 v11, 0xffff0000, v221
    v_fmac_f32 v94, v176, v10
    v_fmac_f32 v110, v176, v11
    v_lshlrev_b32 v10, 16, v222
    v_and_b32 v11, 0xffff0000, v222
    v_fmac_f32 v63, v176, v10
    v_fmac_f32 v79, v176, v11
    v_lshlrev_b32 v10, 16, v223
    v_and_b32 v11, 0xffff0000, v223
    v_fmac_f32 v95, v176, v10
    v_fmac_f32 v111, v176, v11
    s_waitcnt vmcnt(16)
    v_accvgpr_read_b32 v12, a0
    v_lshlrev_b32 v10, 16, v12
    v_and_b32 v11, 0xffff0000, v12
    v_fmac_f32 v48, v178, v10
    v_fmac_f32 v64, v178, v11
    v_accvgpr_read_b32 v12, a1
    v_lshlrev_b32 v10, 16, v12
    v_and_b32 v11, 0xffff0000, v12
    v_fmac_f32 v80, v178, v10
    v_fmac_f32 v96, v178, v11
    v_accvgpr_read_b32 v12, a2
    v_lshlrev_b32 v10, 16, v12
    v_and_b32 v11, 0xffff0000, v12
    v_fmac_f32 v49, v178, v10
    v_fmac_f32 v65, v178, v11
    v_accvgpr_read_b32 v12, a3
    v_lshlrev_b32 v10, 16, v12
    v_and_b32 v11, 0xffff0000, v12
    v_fmac_f32 v81, v178, v10
    v_fmac_f32 v97, v178, v11
    s_waitcnt vmcnt(15)
    v_accvgpr_read_b32 v12, a4
    v_lshlrev_b32 v10, 16, v12
    v_and_b32 v11, 0xffff0000, v12
    v_fmac_f32 v50, v178, v10
    v_fmac_f32 v66, v178, v11
    v_accvgpr_read_b32 v12, a5
    v_lshlrev_b32 v10, 16, v12
    v_and_b32 v11, 0xffff0000, v12
    v_fmac_f32 v82, v178, v10
    v_fmac_f32 v98, v178, v11
    v_accvgpr_read_b32 v12, a6
    v_lshlrev_b32 v10, 16, v12
    v_and_b32 v11, 0xffff0000, v12
    v_fmac_f32 v51, v178, v10
    v_fmac_f32 v67, v178, v11
    v_accvgpr_read_b32 v12, a7
    v_lshlrev_b32 v10, 16, v12
    v_and_b32 v11, 0xffff0000, v12
    v_fmac_f32 v83, v178, v10
    v_fmac_f32 v99, v178, v11
    s_waitcnt vmcnt(14)
    v_accvgpr_read_b32 v12, a8
    v_lshlrev_b32 v10, 16, v12
    v_and_b32 v11, 0xffff0000, v12
    v_fmac_f32 v52, v178, v10
    v_fmac_f32 v68, v178, v11
    v_accvgpr_read_b32 v12, a9
    v_lshlrev_b32 v10, 16, v12
    v_and_b32 v11, 0xffff0000, v12
    v_fmac_f32 v84, v178, v10
    v_fmac_f32 v100, v178, v11
    v_accvgpr_read_b32 v12, a10
    v_lshlrev_b32 v10, 16, v12
    v_and_b32 v11, 0xffff0000, v12
    v_fmac_f32 v53, v178, v10
    v_fmac_f32 v69, v178, v11
    v_accvgpr_read_b32 v12, a11
    v_lshlrev_b32 v10, 16, v12
    v_and_b32 v11, 0xffff0000, v12
    v_fmac_f32 v85, v178, v10
    v_fmac_f32 v101, v178, v11
    s_waitcnt vmcnt(13)
    v_accvgpr_read_b32 v12, a12
    v_lshlrev_b32 v10, 16, v12
    v_and_b32 v11, 0xffff0000, v12
    v_fmac_f32 v54, v178, v10
    v_fmac_f32 v70, v178, v11
    v_accvgpr_read_b32 v12, a13
    v_lshlrev_b32 v10, 16, v12
    v_and_b32 v11, 0xffff0000, v12
    v_fmac_f32 v86, v178, v10
    v_fmac_f32 v102, v178, v11
    v_accvgpr_read_b32 v12, a14
    v_lshlrev_b32 v10, 16, v12
    v_and_b32 v11, 0xffff0000, v12
    v_fmac_f32 v55, v178, v10
    v_fmac_f32 v71, v178, v11
    v_accvgpr_read_b32 v12, a15
    v_lshlrev_b32 v10, 16, v12
    v_and_b32 v11, 0xffff0000, v12
    v_fmac_f32 v87, v178, v10
    v_fmac_f32 v103, v178, v11
    s_waitcnt vmcnt(12)
    v_accvgpr_read_b32 v12, a16
    v_lshlrev_b32 v10, 16, v12
    v_and_b32 v11, 0xffff0000, v12
    v_fmac_f32 v56, v178, v10
    v_fmac_f32 v72, v178, v11
    v_accvgpr_read_b32 v12, a17
    v_lshlrev_b32 v10, 16, v12
    v_and_b32 v11, 0xffff0000, v12
    v_fmac_f32 v88, v178, v10
    v_fmac_f32 v104, v178, v11
    v_accvgpr_read_b32 v12, a18
    v_lshlrev_b32 v10, 16, v12
    v_and_b32 v11, 0xffff0000, v12
    v_fmac_f32 v57, v178, v10
    v_fmac_f32 v73, v178, v11
    v_accvgpr_read_b32 v12, a19
    v_lshlrev_b32 v10, 16, v12
    v_and_b32 v11, 0xffff0000, v12
    v_fmac_f32 v89, v178, v10
    v_fmac_f32 v105, v178, v11
    s_waitcnt vmcnt(11)
    v_accvgpr_read_b32 v12, a20
    v_lshlrev_b32 v10, 16, v12
    v_and_b32 v11, 0xffff0000, v12
    v_fmac_f32 v58, v178, v10
    v_fmac_f32 v74, v178, v11
    v_accvgpr_read_b32 v12, a21
    v_lshlrev_b32 v10, 16, v12
    v_and_b32 v11, 0xffff0000, v12
    v_fmac_f32 v90, v178, v10
    v_fmac_f32 v106, v178, v11
    v_accvgpr_read_b32 v12, a22
    v_lshlrev_b32 v10, 16, v12
    v_and_b32 v11, 0xffff0000, v12
    v_fmac_f32 v59, v178, v10
    v_fmac_f32 v75, v178, v11
    v_accvgpr_read_b32 v12, a23
    v_lshlrev_b32 v10, 16, v12
    v_and_b32 v11, 0xffff0000, v12
    v_fmac_f32 v91, v178, v10
    v_fmac_f32 v107, v178, v11
    s_waitcnt vmcnt(10)
    v_accvgpr_read_b32 v12, a24
    v_lshlrev_b32 v10, 16, v12
    v_and_b32 v11, 0xffff0000, v12
    v_fmac_f32 v60, v178, v10
    v_fmac_f32 v76, v178, v11
    v_accvgpr_read_b32 v12, a25
    v_lshlrev_b32 v10, 16, v12
    v_and_b32 v11, 0xffff0000, v12
    v_fmac_f32 v92, v178, v10
    v_fmac_f32 v108, v178, v11
    v_accvgpr_read_b32 v12, a26
    v_lshlrev_b32 v10, 16, v12
    v_and_b32 v11, 0xffff0000, v12
    v_fmac_f32 v61, v178, v10
    v_fmac_f32 v77, v178, v11
    v_accvgpr_read_b32 v12, a27
    v_lshlrev_b32 v10, 16, v12
    v_and_b32 v11, 0xffff0000, v12
    v_fmac_f32 v93, v178, v10
    v_fmac_f32 v109, v178, v11
    s_waitcnt vmcnt(9)
    v_accvgpr_read_b32 v12, a28
    v_lshlrev_b32 v10, 16, v12
    v_and_b32 v11, 0xffff0000, v12
    v_fmac_f32 v62, v178, v10
    v_fmac_f32 v78, v178, v11
    v_accvgpr_read_b32 v12, a29
    v_lshlrev_b32 v10, 16, v12
    v_and_b32 v11, 0xffff0000, v12
    v_fmac_f32 v94, v178, v10
    v_fmac_f32 v110, v178, v11
    v_accvgpr_read_b32 v12, a30
    v_lshlrev_b32 v10, 16, v12
    v_and_b32 v11, 0xffff0000, v12
    v_fmac_f32 v63, v178, v10
    v_fmac_f32 v79, v178, v11
    v_accvgpr_read_b32 v12, a31
    v_lshlrev_b32 v10, 16, v12
    v_and_b32 v11, 0xffff0000, v12
    v_fmac_f32 v95, v178, v10
    v_fmac_f32 v111, v178, v11
    s_waitcnt vmcnt(8)
    v_max_f32 v10, v13, v180
    v_sub_f32 v13, v13, v10
    v_sub_f32 v180, v180, v10
    v_exp_f32 v13, v13
    v_exp_f32 v180, v180
    s_nop 0
    v_mul_f32 v9, v9, v13
    v_fmac_f32 v9, v180, v181
    v_rcp_f32 v9, v9
    s_nop 0
    v_mul_f32 v8, v13, v9
    v_mul_f32 v180, v180, v9
    v_pk_mul_f32 v[48:49], v[48:49], v[8:9] op_sel_hi:[1,0]
    v_pk_mul_f32 v[50:51], v[50:51], v[8:9] op_sel_hi:[1,0]
    v_pk_mul_f32 v[52:53], v[52:53], v[8:9] op_sel_hi:[1,0]
    v_pk_mul_f32 v[54:55], v[54:55], v[8:9] op_sel_hi:[1,0]
    v_pk_mul_f32 v[56:57], v[56:57], v[8:9] op_sel_hi:[1,0]
    v_pk_mul_f32 v[58:59], v[58:59], v[8:9] op_sel_hi:[1,0]
    v_pk_mul_f32 v[60:61], v[60:61], v[8:9] op_sel_hi:[1,0]
    v_pk_mul_f32 v[62:63], v[62:63], v[8:9] op_sel_hi:[1,0]
    v_pk_mul_f32 v[64:65], v[64:65], v[8:9] op_sel_hi:[1,0]
    v_pk_mul_f32 v[66:67], v[66:67], v[8:9] op_sel_hi:[1,0]
    v_pk_mul_f32 v[68:69], v[68:69], v[8:9] op_sel_hi:[1,0]
    v_pk_mul_f32 v[70:71], v[70:71], v[8:9] op_sel_hi:[1,0]
    v_pk_mul_f32 v[72:73], v[72:73], v[8:9] op_sel_hi:[1,0]
    v_pk_mul_f32 v[74:75], v[74:75], v[8:9] op_sel_hi:[1,0]
    v_pk_mul_f32 v[76:77], v[76:77], v[8:9] op_sel_hi:[1,0]
    v_pk_mul_f32 v[78:79], v[78:79], v[8:9] op_sel_hi:[1,0]
    v_pk_mul_f32 v[80:81], v[80:81], v[8:9] op_sel_hi:[1,0]
    v_pk_mul_f32 v[82:83], v[82:83], v[8:9] op_sel_hi:[1,0]
    v_pk_mul_f32 v[84:85], v[84:85], v[8:9] op_sel_hi:[1,0]
    v_pk_mul_f32 v[86:87], v[86:87], v[8:9] op_sel_hi:[1,0]
    v_pk_mul_f32 v[88:89], v[88:89], v[8:9] op_sel_hi:[1,0]
    v_pk_mul_f32 v[90:91], v[90:91], v[8:9] op_sel_hi:[1,0]
    v_pk_mul_f32 v[92:93], v[92:93], v[8:9] op_sel_hi:[1,0]
    v_pk_mul_f32 v[94:95], v[94:95], v[8:9] op_sel_hi:[1,0]
    v_pk_mul_f32 v[96:97], v[96:97], v[8:9] op_sel_hi:[1,0]
    v_pk_mul_f32 v[98:99], v[98:99], v[8:9] op_sel_hi:[1,0]
    v_pk_mul_f32 v[100:101], v[100:101], v[8:9] op_sel_hi:[1,0]
    v_pk_mul_f32 v[102:103], v[102:103], v[8:9] op_sel_hi:[1,0]
    v_pk_mul_f32 v[104:105], v[104:105], v[8:9] op_sel_hi:[1,0]
    v_pk_mul_f32 v[106:107], v[106:107], v[8:9] op_sel_hi:[1,0]
    v_pk_mul_f32 v[108:109], v[108:109], v[8:9] op_sel_hi:[1,0]
    v_pk_mul_f32 v[110:111], v[110:111], v[8:9] op_sel_hi:[1,0]
    s_waitcnt vmcnt(7)
    v_lshlrev_b32 v10, 16, v112
    v_and_b32 v11, 0xffff0000, v112
    v_fmac_f32 v48, v180, v10
    v_fmac_f32 v64, v180, v11
    v_lshlrev_b32 v10, 16, v113
    v_and_b32 v11, 0xffff0000, v113
    v_fmac_f32 v80, v180, v10
    v_fmac_f32 v96, v180, v11
    v_lshlrev_b32 v10, 16, v114
    v_and_b32 v11, 0xffff0000, v114
    v_fmac_f32 v49, v180, v10
    v_fmac_f32 v65, v180, v11
    v_lshlrev_b32 v10, 16, v115
    v_and_b32 v11, 0xffff0000, v115
    v_fmac_f32 v81, v180, v10
    v_fmac_f32 v97, v180, v11
    s_waitcnt vmcnt(6)
    v_lshlrev_b32 v10, 16, v116
    v_and_b32 v11, 0xffff0000, v116
    v_fmac_f32 v50, v180, v10
    v_fmac_f32 v66, v180, v11
    v_lshlrev_b32 v10, 16, v117
    v_and_b32 v11, 0xffff0000, v117
    v_fmac_f32 v82, v180, v10
    v_fmac_f32 v98, v180, v11
    v_lshlrev_b32 v10, 16, v118
    v_and_b32 v11, 0xffff0000, v118
    v_fmac_f32 v51, v180, v10
    v_fmac_f32 v67, v180, v11
    v_lshlrev_b32 v10, 16, v119
    v_and_b32 v11, 0xffff0000, v119
    v_fmac_f32 v83, v180, v10
    v_fmac_f32 v99, v180, v11
    v_cvt_pk_bf16_f32 v16, v48, v64
    v_cvt_pk_bf16_f32 v17, v80, v96
    v_cvt_pk_bf16_f32 v18, v49, v65
    v_cvt_pk_bf16_f32 v19, v81, v97
    v_cvt_pk_bf16_f32 v20, v50, v66
    v_cvt_pk_bf16_f32 v21, v82, v98
    v_cvt_pk_bf16_f32 v22, v51, v67
    v_cvt_pk_bf16_f32 v23, v83, v99
    buffer_store_dwordx4 v[16:19], v15, s[64:67], s82 offen offset:0 nt
    buffer_store_dwordx4 v[20:23], v15, s[64:67], s82 offen offset:16 nt
    s_waitcnt vmcnt(7)
    v_lshlrev_b32 v10, 16, v120
    v_and_b32 v11, 0xffff0000, v120
    v_fmac_f32 v52, v180, v10
    v_fmac_f32 v68, v180, v11
    v_lshlrev_b32 v10, 16, v121
    v_and_b32 v11, 0xffff0000, v121
    v_fmac_f32 v84, v180, v10
    v_fmac_f32 v100, v180, v11
    v_lshlrev_b32 v10, 16, v122
    v_and_b32 v11, 0xffff0000, v122
    v_fmac_f32 v53, v180, v10
    v_fmac_f32 v69, v180, v11
    v_lshlrev_b32 v10, 16, v123
    v_and_b32 v11, 0xffff0000, v123
    v_fmac_f32 v85, v180, v10
    v_fmac_f32 v101, v180, v11
    s_waitcnt vmcnt(6)
    v_lshlrev_b32 v10, 16, v124
    v_and_b32 v11, 0xffff0000, v124
    v_fmac_f32 v54, v180, v10
    v_fmac_f32 v70, v180, v11
    v_lshlrev_b32 v10, 16, v125
    v_and_b32 v11, 0xffff0000, v125
    v_fmac_f32 v86, v180, v10
    v_fmac_f32 v102, v180, v11
    v_lshlrev_b32 v10, 16, v126
    v_and_b32 v11, 0xffff0000, v126
    v_fmac_f32 v55, v180, v10
    v_fmac_f32 v71, v180, v11
    v_lshlrev_b32 v10, 16, v127
    v_and_b32 v11, 0xffff0000, v127
    v_fmac_f32 v87, v180, v10
    v_fmac_f32 v103, v180, v11
    v_cvt_pk_bf16_f32 v24, v52, v68
    v_cvt_pk_bf16_f32 v25, v84, v100
    v_cvt_pk_bf16_f32 v26, v53, v69
    v_cvt_pk_bf16_f32 v27, v85, v101
    v_cvt_pk_bf16_f32 v28, v54, v70
    v_cvt_pk_bf16_f32 v29, v86, v102
    v_cvt_pk_bf16_f32 v30, v55, v71
    v_cvt_pk_bf16_f32 v31, v87, v103
    buffer_store_dwordx4 v[24:27], v15, s[64:67], s82 offen offset:64 nt
    buffer_store_dwordx4 v[28:31], v15, s[64:67], s82 offen offset:80 nt
    s_waitcnt vmcnt(7)
    v_lshlrev_b32 v10, 16, v128
    v_and_b32 v11, 0xffff0000, v128
    v_fmac_f32 v56, v180, v10
    v_fmac_f32 v72, v180, v11
    v_lshlrev_b32 v10, 16, v129
    v_and_b32 v11, 0xffff0000, v129
    v_fmac_f32 v88, v180, v10
    v_fmac_f32 v104, v180, v11
    v_lshlrev_b32 v10, 16, v130
    v_and_b32 v11, 0xffff0000, v130
    v_fmac_f32 v57, v180, v10
    v_fmac_f32 v73, v180, v11
    v_lshlrev_b32 v10, 16, v131
    v_and_b32 v11, 0xffff0000, v131
    v_fmac_f32 v89, v180, v10
    v_fmac_f32 v105, v180, v11
    s_waitcnt vmcnt(6)
    v_lshlrev_b32 v10, 16, v132
    v_and_b32 v11, 0xffff0000, v132
    v_fmac_f32 v58, v180, v10
    v_fmac_f32 v74, v180, v11
    v_lshlrev_b32 v10, 16, v133
    v_and_b32 v11, 0xffff0000, v133
    v_fmac_f32 v90, v180, v10
    v_fmac_f32 v106, v180, v11
    v_lshlrev_b32 v10, 16, v134
    v_and_b32 v11, 0xffff0000, v134
    v_fmac_f32 v59, v180, v10
    v_fmac_f32 v75, v180, v11
    v_lshlrev_b32 v10, 16, v135
    v_and_b32 v11, 0xffff0000, v135
    v_fmac_f32 v91, v180, v10
    v_fmac_f32 v107, v180, v11
    v_cvt_pk_bf16_f32 v32, v56, v72
    v_cvt_pk_bf16_f32 v33, v88, v104
    v_cvt_pk_bf16_f32 v34, v57, v73
    v_cvt_pk_bf16_f32 v35, v89, v105
    v_cvt_pk_bf16_f32 v36, v58, v74
    v_cvt_pk_bf16_f32 v37, v90, v106
    v_cvt_pk_bf16_f32 v38, v59, v75
    v_cvt_pk_bf16_f32 v39, v91, v107
    buffer_store_dwordx4 v[32:35], v15, s[64:67], s82 offen offset:128 nt
    buffer_store_dwordx4 v[36:39], v15, s[64:67], s82 offen offset:144 nt
    s_waitcnt vmcnt(7)
    v_lshlrev_b32 v10, 16, v136
    v_and_b32 v11, 0xffff0000, v136
    v_fmac_f32 v60, v180, v10
    v_fmac_f32 v76, v180, v11
    v_lshlrev_b32 v10, 16, v137
    v_and_b32 v11, 0xffff0000, v137
    v_fmac_f32 v92, v180, v10
    v_fmac_f32 v108, v180, v11
    v_lshlrev_b32 v10, 16, v138
    v_and_b32 v11, 0xffff0000, v138
    v_fmac_f32 v61, v180, v10
    v_fmac_f32 v77, v180, v11
    v_lshlrev_b32 v10, 16, v139
    v_and_b32 v11, 0xffff0000, v139
    v_fmac_f32 v93, v180, v10
    v_fmac_f32 v109, v180, v11
    s_waitcnt vmcnt(6)
    v_lshlrev_b32 v10, 16, v140
    v_and_b32 v11, 0xffff0000, v140
    v_fmac_f32 v62, v180, v10
    v_fmac_f32 v78, v180, v11
    v_lshlrev_b32 v10, 16, v141
    v_and_b32 v11, 0xffff0000, v141
    v_fmac_f32 v94, v180, v10
    v_fmac_f32 v110, v180, v11
    v_lshlrev_b32 v10, 16, v142
    v_and_b32 v11, 0xffff0000, v142
    v_fmac_f32 v63, v180, v10
    v_fmac_f32 v79, v180, v11
    v_lshlrev_b32 v10, 16, v143
    v_and_b32 v11, 0xffff0000, v143
    v_fmac_f32 v95, v180, v10
    v_fmac_f32 v111, v180, v11
    v_cvt_pk_bf16_f32 v40, v60, v76
    v_cvt_pk_bf16_f32 v41, v92, v108
    v_cvt_pk_bf16_f32 v42, v61, v77
    v_cvt_pk_bf16_f32 v43, v93, v109
    v_cvt_pk_bf16_f32 v44, v62, v78
    v_cvt_pk_bf16_f32 v45, v94, v110
    v_cvt_pk_bf16_f32 v46, v63, v79
    v_cvt_pk_bf16_f32 v47, v95, v111
    buffer_store_dwordx4 v[40:43], v15, s[64:67], s82 offen offset:192 nt
    buffer_store_dwordx4 v[44:47], v15, s[64:67], s82 offen offset:208 nt
L_fin:
L_end:
    s_endpgm
.section .rodata,"a"
.p2align 6
.amdhsa_kernel standalone__kv_cache_quant_int4_int2_kv_with_per_channel_or_per_token_scales__sampling_kernel
  .amdhsa_next_free_vgpr 256
  .amdhsa_next_free_sgpr 102
  .amdhsa_accum_offset 224
  .amdhsa_group_segment_fixed_size 0
  .amdhsa_kernarg_size 80
  .amdhsa_user_sgpr_count 2
  .amdhsa_user_sgpr_kernarg_segment_ptr 1
  .amdhsa_system_sgpr_workgroup_id_x 1
.end_amdhsa_kernel
```
